```python
import torch

def _softmax(x, axis=-1):
    return torch.softmax(x, dim=axis)
def _gelu(x):
    return torch.nn.functional.gelu(x, approximate="tanh")
def _silu(x):
    return torch.nn.functional.silu(x)
def _sigmoid(x):
    return torch.sigmoid(x)
def _layernorm(x, axis=-1, eps=1e-5):
    m = x.mean(dim=axis, keepdim=True)
    v = x.var(dim=axis, keepdim=True, unbiased=False)
    return (x - m) / torch.sqrt(v + eps)
def _scatter_add(tgt, idx, src, axis=0):
    return tgt.clone().index_add_(axis, idx, src)
def _segment_sum(src, seg, n):
    out = torch.zeros((n,) + src.shape[1:], dtype=src.dtype)
    return out.index_add_(0, seg, src)
def _pad(x, pw):
    flat = tuple(v for pair in reversed(pw) for v in pair)
    return torch.nn.functional.pad(x, flat)

kernel_name = 'sequential_preLN__sliding_block__geglu_ffn__prompt'

def setup_inputs():

    _w = (lambda a: (lambda t: t.to(torch.bfloat16) if t.is_floating_point() else t)(torch.as_tensor(a)))
    def _A_setup():
        B, S, D = 1, 2048, 512
        return {
            "x": _w((lambda *s: torch.randn(*s, dtype=torch.bfloat16) * 0.05)(B, S, D)),
            "wqkv": _w((lambda *s: torch.randn(*s, dtype=torch.bfloat16) * 0.05)(D, 3 * D)),
            "wo": _w((lambda *s: torch.randn(*s, dtype=torch.bfloat16) * 0.05)(D, D)),
        }
    _A_in = _A_setup()

    def _B_setup():
        B, S, D, F = 1, 2048, 512, 1376
        return {
            "x": _w((lambda *s: torch.randn(*s, dtype=torch.bfloat16) * 0.05)(B, S, D)),
            "w_gate": _w((lambda *s: torch.randn(*s, dtype=torch.bfloat16) * 0.05)(D, F)),
            "w_up": _w((lambda *s: torch.randn(*s, dtype=torch.bfloat16) * 0.05)(D, F)),
            "w_down": _w((lambda *s: torch.randn(*s, dtype=torch.bfloat16) * 0.05)(F, D)),
        }
    _B_in = _B_setup()

    return {
        "A_x": _A_in["x"],
        "A_wqkv": _A_in["wqkv"],
        "A_wo": _A_in["wo"],
        "B_x": _B_in["x"],
        "B_w_gate": _B_in["w_gate"],
        "B_w_up": _B_in["w_up"],
        "B_w_down": _B_in["w_down"],
    }

def reference(A_x, A_wqkv, A_wo, B_x, B_w_gate, B_w_up, B_w_down):
    def _A_ref(x, wqkv, wo):
        B, S, D = x.shape
        H = 32; Dh = D // H; W = 256
        qkv = (lambda x, *d: x.permute(*d))((x @ wqkv).reshape(B, S, 3, H, Dh), 2, 0, 3, 1, 4)
        q, k, v = qkv[0], qkv[1], qkv[2]
        scores = torch.einsum("bhqd,bhkd->bhqk", q, k) * (Dh ** -0.5)
        idx = torch.arange(S)
        mask = (idx[:, None] - idx[None, :] >= 0) & (idx[:, None] - idx[None, :] < W)
        scores = torch.where(mask[None, None], scores, -1e9)
        p = _softmax(scores, axis=-1)
        o = torch.einsum("bhqk,bhkd->bhqd", p, v)
        return (lambda x, *d: x.permute(*d))(o, 0, 2, 1, 3).reshape(B, S, D) @ wo

    def _B_ref(x, w_gate, w_up, w_down):
        return (_gelu(x @ w_gate) * (x @ w_up)) @ w_down

    x = A_x
    h = x + _A_ref(_layernorm(x, axis=-1), A_wqkv, A_wo)
    h2 = h + _B_ref(_layernorm(h, axis=-1), B_w_gate, B_w_up, B_w_down)
    return h2
```

```asm
; @launch grid=(256,1,1) block=(256,1,1) lds=163840
.amdgcn_target "amdgcn-amd-amdhsa--gfx950"
.set CODE_Q, 9216
.text
.globl sequential_preLN__sliding_block__geglu_ffn__prompt_kernel
.p2align 8
.type sequential_preLN__sliding_block__geglu_ffn__prompt_kernel,@function
sequential_preLN__sliding_block__geglu_ffn__prompt_kernel:
    s_load_dwordx16 s[64:79], s[0:1], 0
    s_load_dwordx4 s[56:59], s[0:1], 64
    s_cmp_ge_u32 s2, 256
    s_cbranch_scc1 L_exit
    s_and_b32 s44, s2, 7
    s_lshl_b32 s44, s44, 1
    s_bfe_u32 s82, s2, 0x10003
    s_add_u32 s44, s44, s82
    s_lshr_b32 s45, s2, 4
    v_lshrrev_b32 v12, 6, v0
    v_and_b32 v1, 63, v0
    v_readfirstlane_b32 s46, v12
    v_lshlrev_b32 v2, 4, v1
    v_lshrrev_b32 v12, 3, v1
    v_and_b32 v13, 7, v1
    v_lshlrev_b32 v14, 1, v12
    v_and_b32 v14, 4, v14
    v_xor_b32 v13, v13, v14
    v_lshlrev_b32 v13, 4, v13
    v_mul_u32_u24 v26, 3072, v12
    v_add_u32 v26, v26, v13
    v_lshl_add_u32 v5, v12, 10, v13
    s_lshl_b32 s93, s44, 2
    s_lshl_b32 s94, s45, 7
    s_add_u32 s94, s94, 1024
    s_lshl_b32 s80, s44, 7
    s_lshl_b32 s81, s45, 3
    s_add_u32 s80, s80, s81
    s_lshl_b32 s81, s46, 1
    s_add_u32 s80, s80, s81
    s_lshl_b32 s80, s80, 10
    s_mov_b32 s10, 2097152
    s_mov_b32 s11, 0x20000
    s_mov_b32 s14, 1572864
    s_mov_b32 s15, 0x20000
    s_waitcnt lgkmcnt(0)
    s_mov_b32 s8, s64
    s_and_b32 s9, s65, 0xffff
    s_mov_b32 s12, s66
    s_and_b32 s13, s67, 0xffff
    buffer_load_dwordx4 v[32:35], v2, s[8:11], s80 offen nt
    buffer_load_dwordx4 v[36:39], v2, s[8:11], s80 offen offset:1024 nt
    s_mov_b32 s40, s58
    s_and_b32 s41, s59, 0xffff
    s_mov_b32 s42, 268435456
    s_mov_b32 s43, 0x20000
    s_mov_b32 s36, s56
    s_and_b32 s37, s57, 0xffff
    s_mov_b32 s38, 256
    s_mov_b32 s39, 0x20000
    s_mov_b32 s16, s68
    s_and_b32 s17, s69, 0xffff
    s_mov_b32 s18, 524288
    s_mov_b32 s19, 0x20000
    s_mov_b32 s20, s72
    s_and_b32 s21, s73, 0xffff
    s_mov_b32 s22, 1409024
    s_mov_b32 s23, 0x20000
    s_mov_b32 s24, s74
    s_and_b32 s25, s75, 0xffff
    s_mov_b32 s26, 1409024
    s_mov_b32 s27, 0x20000
    s_mov_b32 s28, s76
    s_and_b32 s29, s77, 0xffff
    s_mov_b32 s30, 1409024
    s_mov_b32 s31, 0x20000
    s_mov_b32 s32, s78
    s_and_b32 s33, s79, 0xffff
    s_mov_b32 s34, 2097152
    s_mov_b32 s35, 0x20000
    s_sub_u32 s61, s46, 0
    s_mul_i32 s61, s61, 4
    s_add_u32 s61, s61, s93
    s_add_u32 s61, s61, 0
    s_and_b32 s62, s61, 63
    s_lshl_b32 m0, s62, 10
    s_mul_i32 s62, s62, 24576
    s_add_u32 s62, s62, s94
    buffer_load_dwordx4 v26, s[12:15], s62 offen lds
    s_add_u32 s61, s61, 1
    s_and_b32 s62, s61, 63
    s_lshl_b32 m0, s62, 10
    s_mul_i32 s62, s62, 24576
    s_add_u32 s62, s62, s94
    buffer_load_dwordx4 v26, s[12:15], s62 offen lds
    s_add_u32 s61, s61, 1
    s_and_b32 s62, s61, 63
    s_lshl_b32 m0, s62, 10
    s_mul_i32 s62, s62, 24576
    s_add_u32 s62, s62, s94
    buffer_load_dwordx4 v26, s[12:15], s62 offen lds
    s_add_u32 s61, s61, 1
    s_and_b32 s62, s61, 63
    s_lshl_b32 m0, s62, 10
    s_mul_i32 s62, s62, 24576
    s_add_u32 s62, s62, s94
    buffer_load_dwordx4 v26, s[12:15], s62 offen lds
    s_cmp_eq_u32 s46, 1
    s_cbranch_scc1 L_j1_1
    s_cmp_eq_u32 s46, 2
    s_cbranch_scc1 L_j2_2
    s_cmp_eq_u32 s46, 3
    s_cbranch_scc1 L_j3_3
    s_cmp_eq_u32 s2, 0
    s_cbranch_scc0 L_nonp_5
    s_memrealtime s[58:59]
    s_waitcnt lgkmcnt(0)
    s_or_b32 s58, s58, 1
    v_mov_b32 v16, s58
    v_mov_b32 v17, 0
    s_mov_b64 exec, 1
    buffer_store_dword v16, v17, s[36:39], 0 offen sc1
    s_mov_b64 exec, -1
L_nonp_5:
    v_and_b32 v12, 7, v1
    v_lshrrev_b32 v13, 3, v1
    v_lshlrev_b32 v15, 9, v13
    v_lshl_add_u32 v15, v12, 4, v15
    s_lshr_b32 s56, s45, 2
    s_lshl_b32 s57, s44, 2
    s_add_u32 s56, s56, s57
    s_lshl_b32 s56, s56, 15
    s_and_b32 s57, s45, 3
    s_lshl_b32 s57, s57, 7
    s_add_u32 s56, s56, s57
    s_branch L_je_4
L_j1_1:
    v_lshrrev_b32 v12, 3, v1
    v_and_b32 v13, 7, v1
    v_lshlrev_b32 v12, 13, v12
    v_lshl_add_u32 v12, v13, 6, v12
    s_lshl_b32 s56, s44, 9
    s_add_u32 s56, s56, 19922944
    s_mov_b32 exec_hi, 0xffff
    buffer_load_dword v28, v12, s[40:43], s56 offen
    s_mov_b64 exec, -1
    v_lshlrev_b32 v12, 6, v1
    s_lshl_b32 s56, s44, 14
    s_lshl_b32 s57, s45, 10
    s_add_u32 s56, s56, s57
    s_add_u32 s56, s56, 18874368
    s_mov_b32 exec_lo, 0xffff
    s_mov_b32 exec_hi, 0
    buffer_load_dword v28, v12, s[40:43], s56 offen
    s_mov_b64 exec, -1
    s_getpc_b64 s[58:59]
L_pcref:
    s_lshr_b32 s60, s2, 3
    s_mul_i32 s60, s60, 1280
    v_lshlrev_b32 v12, 7, v1
    v_add_u32 v12, s60, v12
    s_mov_b32 exec_lo, 0x3ff
    s_mov_b32 exec_hi, 0
    global_load_dword v29, v12, s[58:59]
    s_mov_b64 exec, -1
    s_branch L_je_4
L_j2_2:
    s_lshl_b32 s56, s2, 4
    v_add_u32 v12, s56, v1
    v_lshrrev_b32 v13, 3, v12
    v_mul_u32_u24 v13, 3072, v13
    v_and_b32 v12, 7, v12
    v_lshl_add_u32 v12, v12, 7, v13
    s_mov_b32 exec_lo, 0xffff
    s_mov_b32 exec_hi, 0
    buffer_load_dword v28, v12, s[12:15], 0 offen
    s_mov_b64 exec, -1
    s_mul_i32 s56, s2, 2048
    v_lshlrev_b32 v29, 7, v1
    s_mov_b32 exec_lo, 0xffff
    s_mov_b32 exec_hi, 0x0
    buffer_load_dword v28, v29, s[16:19], s56 offen
    s_mov_b64 exec, -1
    s_branch L_je_4
L_j3_3:
    s_mul_i32 s56, s2, 2816
    v_lshlrev_b32 v29, 7, v1
    s_mov_b32 exec_lo, 0x3fffff
    s_mov_b32 exec_hi, 0x0
    buffer_load_dword v28, v29, s[20:23], s56 offen
    s_mov_b64 exec, -1
    s_mul_i32 s56, s2, 2816
    v_lshlrev_b32 v31, 7, v1
    s_mov_b32 exec_lo, 0x3fffff
    s_mov_b32 exec_hi, 0x0
    buffer_load_dword v30, v31, s[24:27], s56 offen
    s_mov_b64 exec, -1
L_je_4:
    s_getreg_b32 s50, hwreg(HW_REG_XCC_ID)
    s_and_b32 s50, s50, 15
    s_mov_b32 s49, 0
    s_lshl_b32 s47, s44, 2
    s_add_u32 s47, s47, s46
    s_and_b32 s53, s45, 7
    s_lshr_b32 s52, s46, 1
    s_lshr_b32 s96, s45, 3
    s_lshl_b32 s51, s96, 1
    s_and_b32 s54, s46, 1
    s_add_u32 s51, s51, s54
    s_lshl_b32 s54, s44, 2
    s_add_u32 s51, s51, s54
    s_lshl_b32 s54, s53, 1
    s_add_u32 s54, s54, s52
    s_mul_i32 s68, s45, 43
    s_lshr_b32 s68, s68, 4
    s_mov_b32 s69, 0
    s_mov_b32 s70, 0xffff
    s_mov_b32 s71, 0xffff
    s_lshl_b32 s83, s82, 1
    s_sub_u32 s83, 1, s83
    s_lshl_b32 s86, s45, 6
    s_lshl_b32 s87, s53, 7
    s_lshl_b32 s88, s68, 6
    s_lshl_b32 s99, s53, 2
    s_add_u32 s99, s99, 3
    s_and_b32 s97, s45, 1
    v_lshrrev_b32 v12, 2, v1
    v_and_b32 v13, 3, v1
    v_lshlrev_b32 v13, 4, v13
    v_mul_u32_u24 v3, 3072, v12
    v_add_u32 v3, v3, v13
    v_add_u32 v12, 0, v1
    v_mul_u32_u24 v13, 43691, v12
    v_lshrrev_b32 v13, 19, v13
    v_mul_u32_u24 v14, 12, v13
    v_sub_u32 v14, v12, v14
    v_mul_u32_u24 v13, 2752, v13
    v_lshl_add_u32 v4, v14, 4, v13
    v_add_u32 v12, 64, v1
    v_mul_u32_u24 v13, 43691, v12
    v_lshrrev_b32 v13, 19, v13
    v_mul_u32_u24 v14, 12, v13
    v_sub_u32 v14, v12, v14
    v_mul_u32_u24 v13, 2752, v13
    v_lshl_add_u32 v24, v14, 4, v13
    v_add_u32 v12, 128, v1
    v_mul_u32_u24 v13, 43691, v12
    v_lshrrev_b32 v13, 19, v13
    v_mul_u32_u24 v14, 12, v13
    v_sub_u32 v14, v12, v14
    v_mul_u32_u24 v13, 2752, v13
    v_lshl_add_u32 v25, v14, 4, v13
    v_add_u32 v20, 7168, v5
    v_add_u32 v21, 48128, v3
    v_subrev_u32 v24, 1024, v24
    v_subrev_u32 v25, 2048, v25
    s_cmp_eq_u32 s46, 1
    s_cbranch_scc1 L_x1_6
    s_cmp_eq_u32 s46, 2
    s_cbranch_scc1 L_x2_7
    s_cmp_eq_u32 s46, 3
    s_cbranch_scc1 L_x3_8
    s_waitcnt vmcnt(4)
    s_branch L_xe_9
L_x1_6:
    s_waitcnt vmcnt(7)
    s_branch L_xe_9
L_x2_7:
    s_waitcnt vmcnt(6)
    s_branch L_xe_9
L_x3_8:
    s_waitcnt vmcnt(6)
L_xe_9:
    s_cmp_eq_u32 s46, 0
    s_cbranch_scc0 L_nn0_10
    v_mov_b32 v13, 0
    buffer_load_dword v100, v13, s[36:39], 0 offen sc1
L_nn0_10:
    s_sub_u32 s61, s46, 0
    s_mul_i32 s61, s61, 2
    s_add_u32 s61, s61, s93
    s_add_u32 s61, s61, 16
    s_and_b32 s62, s61, 63
    s_lshl_b32 m0, s62, 10
    s_mul_i32 s62, s62, 24576
    s_add_u32 s62, s62, s94
    buffer_load_dwordx4 v26, s[12:15], s62 offen lds
    s_add_u32 s61, s61, 1
    s_and_b32 s62, s61, 63
    s_lshl_b32 m0, s62, 10
    s_mul_i32 s62, s62, 24576
    s_add_u32 s62, s62, s94
    buffer_load_dwordx4 v26, s[12:15], s62 offen lds
    v_lshlrev_b32 v64, 16, v32
    v_and_b32 v65, 0xffff0000, v32
    v_lshlrev_b32 v66, 16, v33
    v_and_b32 v67, 0xffff0000, v33
    v_lshlrev_b32 v68, 16, v34
    v_and_b32 v69, 0xffff0000, v34
    v_lshlrev_b32 v70, 16, v35
    v_and_b32 v71, 0xffff0000, v35
    v_lshlrev_b32 v72, 16, v36
    v_and_b32 v73, 0xffff0000, v36
    v_lshlrev_b32 v74, 16, v37
    v_and_b32 v75, 0xffff0000, v37
    v_lshlrev_b32 v76, 16, v38
    v_and_b32 v77, 0xffff0000, v38
    v_lshlrev_b32 v78, 16, v39
    v_and_b32 v79, 0xffff0000, v39
    v_add_f32 v80, v64, v65
    v_add_f32 v81, v66, v67
    v_add_f32 v82, v68, v69
    v_add_f32 v83, v70, v71
    v_add_f32 v84, v72, v73
    v_add_f32 v85, v74, v75
    v_add_f32 v86, v76, v77
    v_add_f32 v87, v78, v79
    v_add_f32 v80, v80, v81
    v_add_f32 v82, v82, v83
    v_add_f32 v84, v84, v85
    v_add_f32 v86, v86, v87
    v_add_f32 v80, v80, v82
    v_add_f32 v84, v84, v86
    s_nop 0
    v_add_f32_dpp v80, v80, v80 row_shr:1 row_mask:0xf bank_mask:0xf bound_ctrl:0
    v_add_f32_dpp v84, v84, v84 row_shr:1 row_mask:0xf bank_mask:0xf bound_ctrl:0
    s_nop 0
    v_add_f32_dpp v80, v80, v80 row_shr:2 row_mask:0xf bank_mask:0xf bound_ctrl:0
    v_add_f32_dpp v84, v84, v84 row_shr:2 row_mask:0xf bank_mask:0xf bound_ctrl:0
    s_nop 0
    v_add_f32_dpp v80, v80, v80 row_shr:4 row_mask:0xf bank_mask:0xf bound_ctrl:0
    v_add_f32_dpp v84, v84, v84 row_shr:4 row_mask:0xf bank_mask:0xf bound_ctrl:0
    s_nop 0
    v_add_f32_dpp v80, v80, v80 row_shr:8 row_mask:0xf bank_mask:0xf bound_ctrl:0
    v_add_f32_dpp v84, v84, v84 row_shr:8 row_mask:0xf bank_mask:0xf bound_ctrl:0
    s_nop 0
    v_add_f32_dpp v80, v80, v80 row_bcast:15 row_mask:0xa bank_mask:0xf
    v_add_f32_dpp v84, v84, v84 row_bcast:15 row_mask:0xa bank_mask:0xf
    s_nop 0
    v_add_f32_dpp v80, v80, v80 row_bcast:31 row_mask:0xc bank_mask:0xf
    v_add_f32_dpp v84, v84, v84 row_bcast:31 row_mask:0xc bank_mask:0xf
    v_readlane_b32 s56, v80, 63
    v_readlane_b32 s57, v84, 63
    v_mov_b32 v88, 0xbb000000
    v_fma_f32 v64, s56, v88, v64
    v_fma_f32 v65, s56, v88, v65
    v_fma_f32 v66, s56, v88, v66
    v_fma_f32 v67, s56, v88, v67
    v_fma_f32 v68, s56, v88, v68
    v_fma_f32 v69, s56, v88, v69
    v_fma_f32 v70, s56, v88, v70
    v_fma_f32 v71, s56, v88, v71
    v_fma_f32 v72, s57, v88, v72
    v_fma_f32 v73, s57, v88, v73
    v_fma_f32 v74, s57, v88, v74
    v_fma_f32 v75, s57, v88, v75
    v_fma_f32 v76, s57, v88, v76
    v_fma_f32 v77, s57, v88, v77
    v_fma_f32 v78, s57, v88, v78
    v_fma_f32 v79, s57, v88, v79
    v_mul_f32 v80, v64, v64
    v_mul_f32 v81, v65, v65
    v_mul_f32 v84, v72, v72
    v_mul_f32 v85, v73, v73
    v_fmac_f32 v80, v66, v66
    v_fmac_f32 v81, v67, v67
    v_fmac_f32 v84, v74, v74
    v_fmac_f32 v85, v75, v75
    v_fmac_f32 v80, v68, v68
    v_fmac_f32 v81, v69, v69
    v_fmac_f32 v84, v76, v76
    v_fmac_f32 v85, v77, v77
    v_fmac_f32 v80, v70, v70
    v_fmac_f32 v81, v71, v71
    v_fmac_f32 v84, v78, v78
    v_fmac_f32 v85, v79, v79
    v_add_f32 v80, v80, v81
    v_add_f32 v84, v84, v85
    s_nop 0
    v_add_f32_dpp v80, v80, v80 row_shr:1 row_mask:0xf bank_mask:0xf bound_ctrl:0
    v_add_f32_dpp v84, v84, v84 row_shr:1 row_mask:0xf bank_mask:0xf bound_ctrl:0
    s_nop 0
    v_add_f32_dpp v80, v80, v80 row_shr:2 row_mask:0xf bank_mask:0xf bound_ctrl:0
    v_add_f32_dpp v84, v84, v84 row_shr:2 row_mask:0xf bank_mask:0xf bound_ctrl:0
    s_nop 0
    v_add_f32_dpp v80, v80, v80 row_shr:4 row_mask:0xf bank_mask:0xf bound_ctrl:0
    v_add_f32_dpp v84, v84, v84 row_shr:4 row_mask:0xf bank_mask:0xf bound_ctrl:0
    s_nop 0
    v_add_f32_dpp v80, v80, v80 row_shr:8 row_mask:0xf bank_mask:0xf bound_ctrl:0
    v_add_f32_dpp v84, v84, v84 row_shr:8 row_mask:0xf bank_mask:0xf bound_ctrl:0
    s_nop 0
    v_add_f32_dpp v80, v80, v80 row_bcast:15 row_mask:0xa bank_mask:0xf
    v_add_f32_dpp v84, v84, v84 row_bcast:15 row_mask:0xa bank_mask:0xf
    s_nop 0
    v_add_f32_dpp v80, v80, v80 row_bcast:31 row_mask:0xc bank_mask:0xf
    v_add_f32_dpp v84, v84, v84 row_bcast:31 row_mask:0xc bank_mask:0xf
    v_readlane_b32 s56, v80, 63
    v_readlane_b32 s57, v84, 63
    v_mov_b32 v88, 0x3b000000
    v_mov_b32 v89, 0x3727c5ac
    v_fma_f32 v80, s56, v88, v89
    v_fma_f32 v84, s57, v88, v89
    v_rsq_f32 v80, v80
    v_rsq_f32 v84, v84
    v_mul_f32 v64, v64, v80
    v_mul_f32 v65, v65, v80
    v_mul_f32 v66, v66, v80
    v_mul_f32 v67, v67, v80
    v_mul_f32 v68, v68, v80
    v_mul_f32 v69, v69, v80
    v_mul_f32 v70, v70, v80
    v_mul_f32 v71, v71, v80
    v_mul_f32 v72, v72, v84
    v_mul_f32 v73, v73, v84
    v_mul_f32 v74, v74, v84
    v_mul_f32 v75, v75, v84
    v_mul_f32 v76, v76, v84
    v_mul_f32 v77, v77, v84
    v_mul_f32 v78, v78, v84
    v_mul_f32 v79, v79, v84
    v_cvt_pk_bf16_f32 v112, v64, v65
    v_cvt_pk_bf16_f32 v113, v66, v67
    v_cvt_pk_bf16_f32 v114, v68, v69
    v_cvt_pk_bf16_f32 v115, v70, v71
    v_cvt_pk_bf16_f32 v116, v72, v73
    v_cvt_pk_bf16_f32 v117, v74, v75
    v_cvt_pk_bf16_f32 v118, v76, v77
    v_cvt_pk_bf16_f32 v119, v78, v79
    s_lshl_b32 s56, s46, 11
    s_add_u32 s56, s56, 155648
    v_add_u32 v12, s56, v2
    ds_write_b128 v12, v[112:115]
    ds_write_b128 v12, v[116:119] offset:1024
    s_cmp_eq_u32 s46, 0
    s_cbranch_scc0 L_nn_11
    s_waitcnt vmcnt(2)
    v_readfirstlane_b32 s48, v100
    s_mov_b32 s67, 0
    s_nop 0
    s_cmp_lg_u32 s48, 0
    s_cbranch_scc1 L_npd_13
    v_mov_b32 v13, 0
L_np_12:
    buffer_load_dword v14, v13, s[36:39], 0 offen sc1
    s_waitcnt vmcnt(0)
    v_readfirstlane_b32 s48, v14
    s_add_u32 s67, s67, 1
    s_cmp_gt_u32 s67, 400000
    s_cbranch_scc1 L_npd_13
    s_cmp_eq_u32 s48, 0
    s_cbranch_scc1 L_np_12
L_npd_13:
    s_cmp_gt_u32 s67, 400000
    s_cselect_b32 s56, 1, 0
    s_or_b32 s69, s69, s56
L_nn_11:
    s_waitcnt lgkmcnt(0)
    s_barrier
    s_cmp_eq_u32 s46, 0
    s_cbranch_scc0 L_s1o_14
    v_and_b32 v12, 7, v1
    v_lshrrev_b32 v13, 3, v1
    v_lshlrev_b32 v14, 10, v12
    v_lshl_add_u32 v14, v13, 4, v14
    v_add_u32 v14, 155648, v14
    ds_read_b128 v[32:35], v14 offset:0
    ds_read_b128 v[36:39], v14 offset:128
    ds_read_b128 v[40:43], v14 offset:256
    ds_read_b128 v[44:47], v14 offset:384
    ds_read_b128 v[48:51], v14 offset:512
    ds_read_b128 v[52:55], v14 offset:640
    ds_read_b128 v[56:59], v14 offset:768
    ds_read_b128 v[60:63], v14 offset:896
    v_lshlrev_b32 v15, 9, v13
    v_lshl_add_u32 v15, v12, 4, v15
    s_lshr_b32 s56, s45, 2
    s_lshl_b32 s57, s44, 2
    s_add_u32 s56, s56, s57
    s_lshl_b32 s56, s56, 15
    s_and_b32 s57, s45, 3
    s_lshl_b32 s57, s57, 7
    s_add_u32 s56, s56, s57
    s_waitcnt lgkmcnt(0)
    s_add_u32 s57, s56, 0
    buffer_store_dwordx4 v[32:35], v15, s[40:43], s57 offen sc1
    s_add_u32 s57, s56, 4096
    buffer_store_dwordx4 v[36:39], v15, s[40:43], s57 offen sc1
    s_add_u32 s57, s56, 8192
    buffer_store_dwordx4 v[40:43], v15, s[40:43], s57 offen sc1
    s_add_u32 s57, s56, 12288
    buffer_store_dwordx4 v[44:47], v15, s[40:43], s57 offen sc1
    s_add_u32 s57, s56, 16384
    buffer_store_dwordx4 v[48:51], v15, s[40:43], s57 offen sc1
    s_add_u32 s57, s56, 20480
    buffer_store_dwordx4 v[52:55], v15, s[40:43], s57 offen sc1
    s_add_u32 s57, s56, 24576
    buffer_store_dwordx4 v[56:59], v15, s[40:43], s57 offen sc1
    s_add_u32 s57, s56, 28672
    buffer_store_dwordx4 v[60:63], v15, s[40:43], s57 offen sc1
    s_lshl_b32 s58, s44, 9
    s_add_u32 s58, s58, 19922944
    s_lshl_b32 s59, s45, 3
    s_add_u32 s59, s59, s58
    v_mov_b32 v16, s48
    v_mov_b32 v17, s50
    v_mov_b32 v18, 0
    s_lshl_b32 s60, s44, 11
    s_add_u32 s60, s60, 20185088
    v_lshlrev_b32 v12, 3, v1
    v_lshlrev_b32 v13, 7, v1
    s_waitcnt vmcnt(0)
    s_mov_b64 exec, 1
    buffer_store_dwordx2 v[16:17], v18, s[40:43], s59 offen
    s_mov_b64 exec, 0xffff
    s_mov_b32 s67, 0
    buffer_load_dwordx2 v[100:101], v12, s[40:43], s58 offen sc1
    s_barrier
    s_branch L_s1p2_17
L_s1p_16:
    buffer_load_dwordx2 v[100:101], v12, s[40:43], s58 offen sc1
L_s1p2_17:
    s_waitcnt vmcnt(0)
    v_cmp_eq_u32 vcc, s48, v100
    v_cmp_eq_u32 s[62:63], s50, v101
    s_add_u32 s67, s67, 1
    s_nop 0
    s_and_b64 vcc, vcc, s[62:63]
    s_cmp_eq_u64 vcc, 0xffff
    s_cbranch_scc1 L_s1f_19
    s_cmp_lt_u32 s67, 24
    s_cbranch_scc1 L_s1p_16
    s_cmp_eq_u32 s67, 24
    s_cbranch_scc0 L_s1np_21
    s_lshl_b32 s61, s45, 7
    s_add_u32 s61, s61, s60
    s_mov_b64 exec, 1
    buffer_store_dword v16, v18, s[40:43], s61 offen sc1
    s_mov_b64 exec, 0xffff
L_s1np_21:
    buffer_load_dword v102, v13, s[40:43], s60 offen sc1
    s_waitcnt vmcnt(0)
    v_cmp_eq_u32 vcc, s48, v102
    s_cmp_gt_u32 s67, 400000
    s_cbranch_scc1 L_s1s_18
    s_cmp_eq_u64 vcc, 0xffff
    s_cbranch_scc0 L_s1p_16
L_s1s_18:
    s_mov_b32 s49, 0
    s_cmp_gt_u32 s67, 400000
    s_cselect_b32 s56, 1, 0
    s_or_b32 s69, s69, s56
    s_branch L_s1d_20
L_s1f_19:
    s_mov_b32 s49, 1
L_s1d_20:
    s_mov_b64 exec, -1
    v_mov_b32 v12, s48
    v_mov_b32 v13, s49
    v_mov_b32 v14, 155648
    ds_write_b64 v14, v[12:13]
    s_waitcnt lgkmcnt(0)
    s_branch L_s1e_15
L_s1o_14:
    s_barrier
    s_sub_u32 s61, s46, 1
    s_mul_i32 s61, s61, 14
    s_min_u32 s61, s61, 26
    s_add_u32 s61, s61, s93
    s_add_u32 s61, s61, 24
    s_and_b32 s62, s61, 63
    s_lshl_b32 m0, s62, 10
    s_mul_i32 s62, s62, 24576
    s_add_u32 s62, s62, s94
    buffer_load_dwordx4 v26, s[12:15], s62 offen lds
    s_add_u32 s61, s61, 1
    s_and_b32 s62, s61, 63
    s_lshl_b32 m0, s62, 10
    s_mul_i32 s62, s62, 24576
    s_add_u32 s62, s62, s94
    buffer_load_dwordx4 v26, s[12:15], s62 offen lds
    s_add_u32 s61, s61, 1
    s_and_b32 s62, s61, 63
    s_lshl_b32 m0, s62, 10
    s_mul_i32 s62, s62, 24576
    s_add_u32 s62, s62, s94
    buffer_load_dwordx4 v26, s[12:15], s62 offen lds
    s_add_u32 s61, s61, 1
    s_and_b32 s62, s61, 63
    s_lshl_b32 m0, s62, 10
    s_mul_i32 s62, s62, 24576
    s_add_u32 s62, s62, s94
    buffer_load_dwordx4 v26, s[12:15], s62 offen lds
    s_add_u32 s61, s61, 1
    s_and_b32 s62, s61, 63
    s_lshl_b32 m0, s62, 10
    s_mul_i32 s62, s62, 24576
    s_add_u32 s62, s62, s94
    buffer_load_dwordx4 v26, s[12:15], s62 offen lds
    s_add_u32 s61, s61, 1
    s_and_b32 s62, s61, 63
    s_lshl_b32 m0, s62, 10
    s_mul_i32 s62, s62, 24576
    s_add_u32 s62, s62, s94
    buffer_load_dwordx4 v26, s[12:15], s62 offen lds
    s_add_u32 s61, s61, 1
    s_and_b32 s62, s61, 63
    s_lshl_b32 m0, s62, 10
    s_mul_i32 s62, s62, 24576
    s_add_u32 s62, s62, s94
    buffer_load_dwordx4 v26, s[12:15], s62 offen lds
    s_add_u32 s61, s61, 1
    s_and_b32 s62, s61, 63
    s_lshl_b32 m0, s62, 10
    s_mul_i32 s62, s62, 24576
    s_add_u32 s62, s62, s94
    buffer_load_dwordx4 v26, s[12:15], s62 offen lds
    s_add_u32 s61, s61, 1
    s_and_b32 s62, s61, 63
    s_lshl_b32 m0, s62, 10
    s_mul_i32 s62, s62, 24576
    s_add_u32 s62, s62, s94
    buffer_load_dwordx4 v26, s[12:15], s62 offen lds
    s_add_u32 s61, s61, 1
    s_and_b32 s62, s61, 63
    s_lshl_b32 m0, s62, 10
    s_mul_i32 s62, s62, 24576
    s_add_u32 s62, s62, s94
    buffer_load_dwordx4 v26, s[12:15], s62 offen lds
    s_add_u32 s61, s61, 1
    s_and_b32 s62, s61, 63
    s_lshl_b32 m0, s62, 10
    s_mul_i32 s62, s62, 24576
    s_add_u32 s62, s62, s94
    buffer_load_dwordx4 v26, s[12:15], s62 offen lds
    s_add_u32 s61, s61, 1
    s_and_b32 s62, s61, 63
    s_lshl_b32 m0, s62, 10
    s_mul_i32 s62, s62, 24576
    s_add_u32 s62, s62, s94
    buffer_load_dwordx4 v26, s[12:15], s62 offen lds
    s_add_u32 s61, s61, 1
    s_and_b32 s62, s61, 63
    s_lshl_b32 m0, s62, 10
    s_mul_i32 s62, s62, 24576
    s_add_u32 s62, s62, s94
    buffer_load_dwordx4 v26, s[12:15], s62 offen lds
    s_add_u32 s61, s61, 1
    s_and_b32 s62, s61, 63
    s_lshl_b32 m0, s62, 10
    s_mul_i32 s62, s62, 24576
    s_add_u32 s62, s62, s94
    buffer_load_dwordx4 v26, s[12:15], s62 offen lds
    s_waitcnt vmcnt(0)
L_s1e_15:
    s_barrier
    v_mov_b32 v14, 155648
    ds_read_b64 v[12:13], v14
    s_waitcnt lgkmcnt(0)
    v_readfirstlane_b32 s48, v12
    v_readfirstlane_b32 s49, v13
    s_nop 1
    s_cmp_eq_u32 s49, 1
    s_cselect_b32 s92, 0, 0
    s_mul_i32 s89, s47, 32768
    s_mul_i32 s57, s92, 1
    s_add_u32 s89, s89, s57
    s_add_u32 s90, s89, 0
    buffer_load_dwordx4 a[0:3], v2, s[40:43], s90 offen sc1
    buffer_load_dwordx4 a[4:7], v2, s[40:43], s90 offen offset:1024 sc1
    buffer_load_dwordx4 a[8:11], v2, s[40:43], s90 offen offset:2048 sc1
    buffer_load_dwordx4 a[12:15], v2, s[40:43], s90 offen offset:3072 sc1
    s_add_u32 s90, s89, 4096
    buffer_load_dwordx4 a[16:19], v2, s[40:43], s90 offen sc1
    buffer_load_dwordx4 a[20:23], v2, s[40:43], s90 offen offset:1024 sc1
    buffer_load_dwordx4 a[24:27], v2, s[40:43], s90 offen offset:2048 sc1
    buffer_load_dwordx4 a[28:31], v2, s[40:43], s90 offen offset:3072 sc1
    s_add_u32 s90, s89, 8192
    buffer_load_dwordx4 a[32:35], v2, s[40:43], s90 offen sc1
    buffer_load_dwordx4 a[36:39], v2, s[40:43], s90 offen offset:1024 sc1
    v_lshrrev_b32 v12, 5, v1
    v_lshlrev_b32 v12, 3, v12
    v_bfe_u32 v13, v1, 2, 2
    v_add_u32 v12, v12, v13
    v_lshlrev_b32 v12, 7, v12
    v_lshrrev_b32 v13, 1, v13
    v_lshl_add_u32 v12, v13, 6, v12
    v_bfe_u32 v13, v1, 4, 1
    v_lshl_add_u32 v12, v13, 5, v12
    v_and_b32 v13, 3, v1
    v_lshl_add_u32 v6, v13, 3, v12
    v_xor_b32 v7, 64, v6
    s_cmp_ge_u32 s45, 8
    s_cbranch_scc1 L_kvV_22
    s_mov_b32 s64, s46
    ds_read_b64_tr_b16 v[64:65], v6 offset:0
    ds_read_b64_tr_b16 v[66:67], v6 offset:512
    ds_read_b64_tr_b16 v[68:69], v7 offset:0
    ds_read_b64_tr_b16 v[70:71], v7 offset:512
    ds_read_b64_tr_b16 v[72:73], v6 offset:2048
    ds_read_b64_tr_b16 v[74:75], v6 offset:2560
    ds_read_b64_tr_b16 v[76:77], v7 offset:2048
    ds_read_b64_tr_b16 v[78:79], v7 offset:2560
    s_waitcnt vmcnt(9)
    s_waitcnt lgkmcnt(4)
    v_mfma_f32_32x32x16_bf16 v[32:47], v[64:67], a[0:3], 0
    ds_read_b64_tr_b16 v[80:81], v6 offset:4096
    ds_read_b64_tr_b16 v[82:83], v6 offset:4608
    buffer_load_dwordx4 a[40:43], v2, s[40:43], s90 offen offset:2048 sc1
    v_mov_b32 v104, 0x3f803f80
    v_accvgpr_write_b32 a128, v104
    v_accvgpr_write_b32 a129, v104
    v_accvgpr_write_b32 a130, v104
    v_mfma_f32_32x32x16_bf16 v[48:63], v[68:71], a[0:3], 0
    ds_read_b64_tr_b16 v[84:85], v7 offset:4096
    ds_read_b64_tr_b16 v[86:87], v7 offset:4608
    v_accvgpr_write_b32 a131, v104
    v_accvgpr_write_b32 a132, v104
    v_accvgpr_write_b32 a133, v104
    v_accvgpr_write_b32 a134, v104
    s_waitcnt vmcnt(9)
    s_waitcnt lgkmcnt(4)
    v_mfma_f32_32x32x16_bf16 v[32:47], v[72:75], a[4:7], v[32:47]
    ds_read_b64_tr_b16 v[64:65], v6 offset:6144
    ds_read_b64_tr_b16 v[66:67], v6 offset:6656
    buffer_load_dwordx4 a[44:47], v2, s[40:43], s90 offen offset:3072 sc1
    v_accvgpr_write_b32 a135, v104
    v_accvgpr_write_b32 a136, v104
    v_accvgpr_write_b32 a137, v104
    v_mfma_f32_32x32x16_bf16 v[48:63], v[76:79], a[4:7], v[48:63]
    ds_read_b64_tr_b16 v[68:69], v7 offset:6144
    ds_read_b64_tr_b16 v[70:71], v7 offset:6656
    v_accvgpr_write_b32 a138, v104
    v_accvgpr_write_b32 a139, v104
    v_accvgpr_write_b32 a140, v104
    v_accvgpr_write_b32 a141, v104
    s_waitcnt vmcnt(9)
    s_waitcnt lgkmcnt(4)
    v_mfma_f32_32x32x16_bf16 v[32:47], v[80:83], a[8:11], v[32:47]
    ds_read_b64_tr_b16 v[72:73], v6 offset:8192
    ds_read_b64_tr_b16 v[74:75], v6 offset:8704
    s_add_u32 s90, s89, 12288
    buffer_load_dwordx4 a[48:51], v2, s[40:43], s90 offen sc1
    v_accvgpr_write_b32 a142, v104
    v_accvgpr_write_b32 a143, v104
    v_accvgpr_write_b32 a144, v104
    v_accvgpr_write_b32 a145, v104
    v_mfma_f32_32x32x16_bf16 v[48:63], v[84:87], a[8:11], v[48:63]
    ds_read_b64_tr_b16 v[76:77], v7 offset:8192
    ds_read_b64_tr_b16 v[78:79], v7 offset:8704
    v_accvgpr_write_b32 a146, v104
    v_accvgpr_write_b32 a147, v104
    v_accvgpr_write_b32 a148, v104
    s_waitcnt vmcnt(9)
    s_waitcnt lgkmcnt(4)
    v_mfma_f32_32x32x16_bf16 v[32:47], v[64:67], a[12:15], v[32:47]
    ds_read_b64_tr_b16 v[80:81], v6 offset:10240
    ds_read_b64_tr_b16 v[82:83], v6 offset:10752
    buffer_load_dwordx4 a[52:55], v2, s[40:43], s90 offen offset:1024 sc1
    v_accvgpr_write_b32 a149, v104
    v_accvgpr_write_b32 a150, v104
    v_accvgpr_write_b32 a151, v104
    v_accvgpr_write_b32 a152, v104
    v_mfma_f32_32x32x16_bf16 v[48:63], v[68:71], a[12:15], v[48:63]
    ds_read_b64_tr_b16 v[84:85], v7 offset:10240
    ds_read_b64_tr_b16 v[86:87], v7 offset:10752
    v_accvgpr_write_b32 a153, v104
    v_accvgpr_write_b32 a154, v104
    v_accvgpr_write_b32 a155, v104
    s_waitcnt vmcnt(9)
    s_waitcnt lgkmcnt(4)
    v_mfma_f32_32x32x16_bf16 v[32:47], v[72:75], a[16:19], v[32:47]
    ds_read_b64_tr_b16 v[64:65], v6 offset:12288
    ds_read_b64_tr_b16 v[66:67], v6 offset:12800
    buffer_load_dwordx4 a[56:59], v2, s[40:43], s90 offen offset:2048 sc1
    v_accvgpr_write_b32 a156, v104
    v_accvgpr_write_b32 a157, v104
    v_accvgpr_write_b32 a158, v104
    v_accvgpr_write_b32 a159, v104
    v_mfma_f32_32x32x16_bf16 v[48:63], v[76:79], a[16:19], v[48:63]
    ds_read_b64_tr_b16 v[68:69], v7 offset:12288
    ds_read_b64_tr_b16 v[70:71], v7 offset:12800
    v_accvgpr_write_b32 a160, v104
    v_accvgpr_write_b32 a161, v104
    v_accvgpr_write_b32 a162, v104
    v_accvgpr_write_b32 a163, v104
    s_waitcnt vmcnt(9)
    s_waitcnt lgkmcnt(4)
    v_mfma_f32_32x32x16_bf16 v[32:47], v[80:83], a[20:23], v[32:47]
    ds_read_b64_tr_b16 v[72:73], v6 offset:14336
    ds_read_b64_tr_b16 v[74:75], v6 offset:14848
    buffer_load_dwordx4 a[60:63], v2, s[40:43], s90 offen offset:3072 sc1
    v_accvgpr_write_b32 a164, v104
    v_accvgpr_write_b32 a165, v104
    v_accvgpr_write_b32 a166, v104
    v_mfma_f32_32x32x16_bf16 v[48:63], v[84:87], a[20:23], v[48:63]
    ds_read_b64_tr_b16 v[76:77], v7 offset:14336
    ds_read_b64_tr_b16 v[78:79], v7 offset:14848
    v_accvgpr_write_b32 a167, v104
    v_accvgpr_write_b32 a168, v104
    v_accvgpr_write_b32 a169, v104
    v_accvgpr_write_b32 a170, v104
    s_waitcnt vmcnt(9)
    s_waitcnt lgkmcnt(4)
    v_mfma_f32_32x32x16_bf16 v[32:47], v[64:67], a[24:27], v[32:47]
    ds_read_b64_tr_b16 v[80:81], v6 offset:16384
    ds_read_b64_tr_b16 v[82:83], v6 offset:16896
    s_add_u32 s90, s89, 16384
    buffer_load_dwordx4 a[64:67], v2, s[40:43], s90 offen sc1
    v_accvgpr_write_b32 a171, v104
    v_accvgpr_write_b32 a172, v104
    v_accvgpr_write_b32 a173, v104
    v_mfma_f32_32x32x16_bf16 v[48:63], v[68:71], a[24:27], v[48:63]
    ds_read_b64_tr_b16 v[84:85], v7 offset:16384
    ds_read_b64_tr_b16 v[86:87], v7 offset:16896
    v_accvgpr_write_b32 a174, v104
    v_accvgpr_write_b32 a175, v104
    v_accvgpr_write_b32 a176, v104
    v_accvgpr_write_b32 a177, v104
    s_waitcnt vmcnt(9)
    s_waitcnt lgkmcnt(4)
    v_mfma_f32_32x32x16_bf16 v[32:47], v[72:75], a[28:31], v[32:47]
    ds_read_b64_tr_b16 v[64:65], v6 offset:18432
    ds_read_b64_tr_b16 v[66:67], v6 offset:18944
    buffer_load_dwordx4 a[68:71], v2, s[40:43], s90 offen offset:1024 sc1
    v_accvgpr_write_b32 a178, v104
    v_accvgpr_write_b32 a179, v104
    v_accvgpr_write_b32 a180, v104
    v_accvgpr_write_b32 a181, v104
    v_mfma_f32_32x32x16_bf16 v[48:63], v[76:79], a[28:31], v[48:63]
    ds_read_b64_tr_b16 v[68:69], v7 offset:18432
    ds_read_b64_tr_b16 v[70:71], v7 offset:18944
    v_accvgpr_write_b32 a182, v104
    v_accvgpr_write_b32 a183, v104
    v_accvgpr_write_b32 a184, v104
    s_waitcnt vmcnt(9)
    s_waitcnt lgkmcnt(4)
    v_mfma_f32_32x32x16_bf16 v[32:47], v[80:83], a[32:35], v[32:47]
    ds_read_b64_tr_b16 v[72:73], v6 offset:20480
    ds_read_b64_tr_b16 v[74:75], v6 offset:20992
    buffer_load_dwordx4 a[72:75], v2, s[40:43], s90 offen offset:2048 sc1
    v_accvgpr_write_b32 a185, v104
    v_accvgpr_write_b32 a186, v104
    v_accvgpr_write_b32 a187, v104
    v_accvgpr_write_b32 a188, v104
    v_mfma_f32_32x32x16_bf16 v[48:63], v[84:87], a[32:35], v[48:63]
    ds_read_b64_tr_b16 v[76:77], v7 offset:20480
    ds_read_b64_tr_b16 v[78:79], v7 offset:20992
    v_accvgpr_write_b32 a189, v104
    v_accvgpr_write_b32 a190, v104
    v_accvgpr_write_b32 a191, v104
    s_waitcnt vmcnt(9)
    s_waitcnt lgkmcnt(4)
    v_mfma_f32_32x32x16_bf16 v[32:47], v[64:67], a[36:39], v[32:47]
    ds_read_b64_tr_b16 v[80:81], v6 offset:22528
    ds_read_b64_tr_b16 v[82:83], v6 offset:23040
    buffer_load_dwordx4 a[76:79], v2, s[40:43], s90 offen offset:3072 sc1
    v_accvgpr_write_b32 a192, v104
    v_accvgpr_write_b32 a193, v104
    v_accvgpr_write_b32 a194, v104
    v_accvgpr_write_b32 a195, v104
    v_mfma_f32_32x32x16_bf16 v[48:63], v[68:71], a[36:39], v[48:63]
    ds_read_b64_tr_b16 v[84:85], v7 offset:22528
    ds_read_b64_tr_b16 v[86:87], v7 offset:23040
    s_mul_i32 s56, s64, 4
    s_mul_i32 s57, s82, 3
    s_add_u32 s56, s56, s57
    s_mul_i32 s84, s83, 2048
    s_mul_i32 s85, s83, 98304
    s_mul_i32 s57, s97, 2
    s_mul_i32 s57, s57, s83
    s_add_u32 s56, s56, s57
    s_mul_i32 s95, s97, 4
    s_mul_i32 s95, s95, s83
    s_mul_i32 s65, s56, 2048
    s_add_u32 s65, s65, 65536
    s_mul_i32 s66, s56, 98304
    s_add_u32 s66, s66, s86
    s_mov_b32 m0, s65
    s_nop 0
    buffer_load_dwordx4 v3, s[12:15], s66 offen lds
    v_accvgpr_write_b32 a196, v104
    v_accvgpr_write_b32 a197, v104
    v_accvgpr_write_b32 a198, v104
    v_accvgpr_write_b32 a199, v104
    s_waitcnt vmcnt(10)
    s_waitcnt lgkmcnt(4)
    v_mfma_f32_32x32x16_bf16 v[32:47], v[72:75], a[40:43], v[32:47]
    ds_read_b64_tr_b16 v[64:65], v6 offset:24576
    ds_read_b64_tr_b16 v[66:67], v6 offset:25088
    s_add_u32 s90, s89, 20480
    buffer_load_dwordx4 a[80:83], v2, s[40:43], s90 offen sc1
    v_accvgpr_write_b32 a200, v104
    v_accvgpr_write_b32 a201, v104
    v_accvgpr_write_b32 a202, v104
    v_mfma_f32_32x32x16_bf16 v[48:63], v[76:79], a[40:43], v[48:63]
    ds_read_b64_tr_b16 v[68:69], v7 offset:24576
    ds_read_b64_tr_b16 v[70:71], v7 offset:25088
    v_accvgpr_write_b32 a203, v104
    v_accvgpr_write_b32 a204, v104
    v_accvgpr_write_b32 a205, v104
    v_accvgpr_write_b32 a206, v104
    s_waitcnt vmcnt(10)
    s_waitcnt lgkmcnt(4)
    v_mfma_f32_32x32x16_bf16 v[32:47], v[80:83], a[44:47], v[32:47]
    ds_read_b64_tr_b16 v[72:73], v6 offset:26624
    ds_read_b64_tr_b16 v[74:75], v6 offset:27136
    buffer_load_dwordx4 a[84:87], v2, s[40:43], s90 offen offset:1024 sc1
    v_accvgpr_write_b32 a207, v104
    v_accvgpr_write_b32 a208, v104
    v_accvgpr_write_b32 a209, v104
    v_accvgpr_write_b32 a210, v104
    v_mfma_f32_32x32x16_bf16 v[48:63], v[84:87], a[44:47], v[48:63]
    ds_read_b64_tr_b16 v[76:77], v7 offset:26624
    ds_read_b64_tr_b16 v[78:79], v7 offset:27136
    v_accvgpr_write_b32 a211, v104
    v_accvgpr_write_b32 a212, v104
    v_accvgpr_write_b32 a213, v104
    s_waitcnt vmcnt(10)
    s_waitcnt lgkmcnt(4)
    v_mfma_f32_32x32x16_bf16 v[32:47], v[64:67], a[48:51], v[32:47]
    ds_read_b64_tr_b16 v[80:81], v6 offset:28672
    ds_read_b64_tr_b16 v[82:83], v6 offset:29184
    buffer_load_dwordx4 a[88:91], v2, s[40:43], s90 offen offset:2048 sc1
    buffer_load_dwordx4 v21, s[12:15], s66 offen offset:1024 lds
    s_add_u32 s65, s65, s84
    s_add_u32 s66, s66, s85
    s_mov_b32 m0, s65
    v_accvgpr_write_b32 a214, v104
    v_accvgpr_write_b32 a215, v104
    v_accvgpr_write_b32 a216, v104
    v_accvgpr_write_b32 a217, v104
    v_mfma_f32_32x32x16_bf16 v[48:63], v[68:71], a[48:51], v[48:63]
    ds_read_b64_tr_b16 v[84:85], v7 offset:28672
    ds_read_b64_tr_b16 v[86:87], v7 offset:29184
    v_accvgpr_write_b32 a218, v104
    v_accvgpr_write_b32 a219, v104
    v_accvgpr_write_b32 a220, v104
    s_waitcnt vmcnt(11)
    s_waitcnt lgkmcnt(4)
    v_mfma_f32_32x32x16_bf16 v[32:47], v[72:75], a[52:55], v[32:47]
    ds_read_b64_tr_b16 v[64:65], v6 offset:30720
    ds_read_b64_tr_b16 v[66:67], v6 offset:31232
    buffer_load_dwordx4 a[92:95], v2, s[40:43], s90 offen offset:3072 sc1
    v_accvgpr_write_b32 a221, v104
    v_accvgpr_write_b32 a222, v104
    v_accvgpr_write_b32 a223, v104
    v_accvgpr_write_b32 a224, v104
    v_mfma_f32_32x32x16_bf16 v[48:63], v[76:79], a[52:55], v[48:63]
    ds_read_b64_tr_b16 v[68:69], v7 offset:30720
    ds_read_b64_tr_b16 v[70:71], v7 offset:31232
    v_accvgpr_write_b32 a225, v104
    v_accvgpr_write_b32 a226, v104
    v_accvgpr_write_b32 a227, v104
    v_accvgpr_write_b32 a228, v104
    s_waitcnt vmcnt(11)
    s_waitcnt lgkmcnt(4)
    v_mfma_f32_32x32x16_bf16 v[32:47], v[80:83], a[56:59], v[32:47]
    ds_read_b64_tr_b16 v[72:73], v6 offset:32768
    ds_read_b64_tr_b16 v[74:75], v6 offset:33280
    s_add_u32 s90, s89, 24576
    buffer_load_dwordx4 a[96:99], v2, s[40:43], s90 offen sc1
    v_accvgpr_write_b32 a229, v104
    v_accvgpr_write_b32 a230, v104
    v_accvgpr_write_b32 a231, v104
    v_mfma_f32_32x32x16_bf16 v[48:63], v[84:87], a[56:59], v[48:63]
    ds_read_b64_tr_b16 v[76:77], v7 offset:32768
    ds_read_b64_tr_b16 v[78:79], v7 offset:33280
    buffer_load_dwordx4 v3, s[12:15], s66 offen lds
    v_accvgpr_write_b32 a232, v104
    v_accvgpr_write_b32 a233, v104
    v_accvgpr_write_b32 a234, v104
    v_accvgpr_write_b32 a235, v104
    s_waitcnt vmcnt(12)
    s_waitcnt lgkmcnt(4)
    v_mfma_f32_32x32x16_bf16 v[32:47], v[64:67], a[60:63], v[32:47]
    ds_read_b64_tr_b16 v[80:81], v6 offset:34816
    ds_read_b64_tr_b16 v[82:83], v6 offset:35328
    buffer_load_dwordx4 a[100:103], v2, s[40:43], s90 offen offset:1024 sc1
    v_accvgpr_write_b32 a236, v104
    v_accvgpr_write_b32 a237, v104
    v_accvgpr_write_b32 a238, v104
    v_mfma_f32_32x32x16_bf16 v[48:63], v[68:71], a[60:63], v[48:63]
    ds_read_b64_tr_b16 v[84:85], v7 offset:34816
    ds_read_b64_tr_b16 v[86:87], v7 offset:35328
    v_accvgpr_write_b32 a239, v104
    v_accvgpr_write_b32 a240, v104
    v_accvgpr_write_b32 a241, v104
    v_accvgpr_write_b32 a242, v104
    s_waitcnt vmcnt(12)
    s_waitcnt lgkmcnt(4)
    v_mfma_f32_32x32x16_bf16 v[32:47], v[72:75], a[64:67], v[32:47]
    ds_read_b64_tr_b16 v[64:65], v6 offset:36864
    ds_read_b64_tr_b16 v[66:67], v6 offset:37376
    buffer_load_dwordx4 a[104:107], v2, s[40:43], s90 offen offset:2048 sc1
    v_accvgpr_write_b32 a243, v104
    v_accvgpr_write_b32 a244, v104
    v_accvgpr_write_b32 a245, v104
    v_accvgpr_write_b32 a246, v104
    v_mfma_f32_32x32x16_bf16 v[48:63], v[76:79], a[64:67], v[48:63]
    ds_read_b64_tr_b16 v[68:69], v7 offset:36864
    ds_read_b64_tr_b16 v[70:71], v7 offset:37376
    v_accvgpr_write_b32 a247, v104
    v_accvgpr_write_b32 a248, v104
    v_accvgpr_write_b32 a249, v104
    s_waitcnt vmcnt(12)
    s_waitcnt lgkmcnt(4)
    v_mfma_f32_32x32x16_bf16 v[32:47], v[80:83], a[68:71], v[32:47]
    ds_read_b64_tr_b16 v[72:73], v6 offset:38912
    ds_read_b64_tr_b16 v[74:75], v6 offset:39424
    buffer_load_dwordx4 a[108:111], v2, s[40:43], s90 offen offset:3072 sc1
    buffer_load_dwordx4 v21, s[12:15], s66 offen offset:1024 lds
    s_sub_u32 s56, s83, s95
    s_mul_i32 s57, s56, 2048
    s_add_u32 s65, s65, s57
    s_mul_i32 s57, s56, 98304
    s_add_u32 s66, s66, s57
    s_mov_b32 m0, s65
    v_accvgpr_write_b32 a250, v104
    v_accvgpr_write_b32 a251, v104
    v_accvgpr_write_b32 a252, v104
    v_accvgpr_write_b32 a253, v104
    v_mfma_f32_32x32x16_bf16 v[48:63], v[84:87], a[68:71], v[48:63]
    ds_read_b64_tr_b16 v[76:77], v7 offset:38912
    ds_read_b64_tr_b16 v[78:79], v7 offset:39424
    v_accvgpr_write_b32 a254, v104
    v_accvgpr_write_b32 a255, v104
    v_mov_b32 v240, v104
    s_waitcnt vmcnt(13)
    s_waitcnt lgkmcnt(4)
    v_mfma_f32_32x32x16_bf16 v[32:47], v[64:67], a[72:75], v[32:47]
    ds_read_b64_tr_b16 v[80:81], v6 offset:40960
    ds_read_b64_tr_b16 v[82:83], v6 offset:41472
    s_add_u32 s90, s89, 28672
    buffer_load_dwordx4 a[112:115], v2, s[40:43], s90 offen sc1
    v_mov_b32 v241, v104
    v_mov_b32 v242, v104
    v_mov_b32 v243, v104
    v_mov_b32 v244, v104
    v_mfma_f32_32x32x16_bf16 v[48:63], v[68:71], a[72:75], v[48:63]
    ds_read_b64_tr_b16 v[84:85], v7 offset:40960
    ds_read_b64_tr_b16 v[86:87], v7 offset:41472
    v_mov_b32 v245, v104
    v_mov_b32 v246, v104
    v_mov_b32 v247, v104
    v_mov_b32 v248, v104
    s_waitcnt vmcnt(13)
    s_waitcnt lgkmcnt(4)
    v_mfma_f32_32x32x16_bf16 v[32:47], v[72:75], a[76:79], v[32:47]
    ds_read_b64_tr_b16 v[64:65], v6 offset:43008
    ds_read_b64_tr_b16 v[66:67], v6 offset:43520
    buffer_load_dwordx4 a[116:119], v2, s[40:43], s90 offen offset:1024 sc1
    v_mov_b32 v249, v104
    v_mov_b32 v250, v104
    v_mov_b32 v251, v104
    v_mfma_f32_32x32x16_bf16 v[48:63], v[76:79], a[76:79], v[48:63]
    ds_read_b64_tr_b16 v[68:69], v7 offset:43008
    ds_read_b64_tr_b16 v[70:71], v7 offset:43520
    buffer_load_dwordx4 v3, s[12:15], s66 offen lds
    v_mov_b32 v252, v104
    v_mov_b32 v253, v104
    v_mov_b32 v254, v104
    v_mov_b32 v255, v104
    s_waitcnt vmcnt(13)
    s_waitcnt lgkmcnt(4)
    v_mfma_f32_32x32x16_bf16 v[32:47], v[80:83], a[80:83], v[32:47]
    ds_read_b64_tr_b16 v[72:73], v6 offset:45056
    ds_read_b64_tr_b16 v[74:75], v6 offset:45568
    buffer_load_dwordx4 a[120:123], v2, s[40:43], s90 offen offset:2048 sc1
    v_and_b32 v105, 31, v1
    v_lshrrev_b32 v106, 5, v1
    v_lshlrev_b32 v106, 2, v106
    v_mfma_f32_32x32x16_bf16 v[48:63], v[84:87], a[80:83], v[48:63]
    ds_read_b64_tr_b16 v[76:77], v7 offset:45056
    ds_read_b64_tr_b16 v[78:79], v7 offset:45568
    v_sub_u32 v105, v105, v106
    v_mov_b32 v107, 0xf149f2ca
    v_mov_b32 v111, 0xffff
    v_subrev_u32 v108, 0, v105
    s_waitcnt vmcnt(13)
    s_waitcnt lgkmcnt(4)
    v_mfma_f32_32x32x16_bf16 v[32:47], v[64:67], a[84:87], v[32:47]
    ds_read_b64_tr_b16 v[80:81], v6 offset:47104
    ds_read_b64_tr_b16 v[82:83], v6 offset:47616
    buffer_load_dwordx4 a[124:127], v2, s[40:43], s90 offen offset:3072 sc1
    v_ashrrev_i32 v109, 31, v108
    v_and_b32 v216, v109, v107
    v_bfi_b32 v200, v109, 0, v107
    v_subrev_u32 v108, 1, v105
    v_mfma_f32_32x32x16_bf16 v[48:63], v[68:71], a[84:87], v[48:63]
    ds_read_b64_tr_b16 v[84:85], v7 offset:47104
    ds_read_b64_tr_b16 v[86:87], v7 offset:47616
    v_ashrrev_i32 v110, 31, v108
    v_and_b32 v217, v110, v107
    v_bfi_b32 v201, v110, 0, v107
    s_waitcnt vmcnt(13)
    s_waitcnt lgkmcnt(4)
    v_mfma_f32_32x32x16_bf16 v[32:47], v[72:75], a[88:91], v[32:47]
    ds_read_b64_tr_b16 v[64:65], v6 offset:49152
    ds_read_b64_tr_b16 v[66:67], v6 offset:49664
    buffer_load_dwordx4 v21, s[12:15], s66 offen offset:1024 lds
    s_add_u32 s65, s65, s84
    s_add_u32 s66, s66, s85
    s_mov_b32 m0, s65
    v_bfi_b32 v106, v111, v109, v110
    v_not_b32 v232, v106
    v_subrev_u32 v108, 2, v105
    v_ashrrev_i32 v109, 31, v108
    v_mfma_f32_32x32x16_bf16 v[48:63], v[76:79], a[88:91], v[48:63]
    ds_read_b64_tr_b16 v[68:69], v7 offset:49152
    ds_read_b64_tr_b16 v[70:71], v7 offset:49664
    v_and_b32 v218, v109, v107
    v_bfi_b32 v202, v109, 0, v107
    v_subrev_u32 v108, 3, v105
    v_ashrrev_i32 v110, 31, v108
    s_waitcnt vmcnt(12)
    s_waitcnt lgkmcnt(4)
    v_mfma_f32_32x32x16_bf16 v[32:47], v[80:83], a[92:95], v[32:47]
    ds_read_b64_tr_b16 v[72:73], v6 offset:51200
    ds_read_b64_tr_b16 v[74:75], v6 offset:51712
    v_and_b32 v219, v110, v107
    v_bfi_b32 v203, v110, 0, v107
    v_bfi_b32 v106, v111, v109, v110
    v_mfma_f32_32x32x16_bf16 v[48:63], v[84:87], a[92:95], v[48:63]
    ds_read_b64_tr_b16 v[76:77], v7 offset:51200
    ds_read_b64_tr_b16 v[78:79], v7 offset:51712
    v_not_b32 v233, v106
    v_subrev_u32 v108, 8, v105
    v_ashrrev_i32 v109, 31, v108
    v_and_b32 v220, v109, v107
    s_waitcnt vmcnt(11)
    s_waitcnt lgkmcnt(4)
    v_mfma_f32_32x32x16_bf16 v[32:47], v[64:67], a[96:99], v[32:47]
    ds_read_b64_tr_b16 v[80:81], v6 offset:53248
    ds_read_b64_tr_b16 v[82:83], v6 offset:53760
    v_bfi_b32 v204, v109, 0, v107
    v_subrev_u32 v108, 9, v105
    v_ashrrev_i32 v110, 31, v108
    v_mfma_f32_32x32x16_bf16 v[48:63], v[68:71], a[96:99], v[48:63]
    ds_read_b64_tr_b16 v[84:85], v7 offset:53248
    ds_read_b64_tr_b16 v[86:87], v7 offset:53760
    buffer_load_dwordx4 v3, s[12:15], s66 offen lds
    v_and_b32 v221, v110, v107
    v_bfi_b32 v205, v110, 0, v107
    v_bfi_b32 v106, v111, v109, v110
    v_not_b32 v234, v106
    s_waitcnt vmcnt(10)
    s_waitcnt lgkmcnt(4)
    v_mfma_f32_32x32x16_bf16 v[32:47], v[72:75], a[100:103], v[32:47]
    ds_read_b64_tr_b16 v[64:65], v6 offset:55296
    ds_read_b64_tr_b16 v[66:67], v6 offset:55808
    v_subrev_u32 v108, 10, v105
    v_ashrrev_i32 v109, 31, v108
    v_and_b32 v222, v109, v107
    v_bfi_b32 v206, v109, 0, v107
    v_mfma_f32_32x32x16_bf16 v[48:63], v[76:79], a[100:103], v[48:63]
    ds_read_b64_tr_b16 v[68:69], v7 offset:55296
    ds_read_b64_tr_b16 v[70:71], v7 offset:55808
    v_subrev_u32 v108, 11, v105
    v_ashrrev_i32 v110, 31, v108
    v_and_b32 v223, v110, v107
    s_waitcnt vmcnt(9)
    s_waitcnt lgkmcnt(4)
    v_mfma_f32_32x32x16_bf16 v[32:47], v[80:83], a[104:107], v[32:47]
    ds_read_b64_tr_b16 v[72:73], v6 offset:57344
    ds_read_b64_tr_b16 v[74:75], v6 offset:57856
    v_bfi_b32 v207, v110, 0, v107
    v_bfi_b32 v106, v111, v109, v110
    v_not_b32 v235, v106
    v_subrev_u32 v108, 16, v105
    v_mfma_f32_32x32x16_bf16 v[48:63], v[84:87], a[104:107], v[48:63]
    ds_read_b64_tr_b16 v[76:77], v7 offset:57344
    ds_read_b64_tr_b16 v[78:79], v7 offset:57856
    v_ashrrev_i32 v109, 31, v108
    v_and_b32 v224, v109, v107
    v_bfi_b32 v208, v109, 0, v107
    s_waitcnt vmcnt(8)
    s_waitcnt lgkmcnt(4)
    v_mfma_f32_32x32x16_bf16 v[32:47], v[64:67], a[108:111], v[32:47]
    ds_read_b64_tr_b16 v[80:81], v6 offset:59392
    ds_read_b64_tr_b16 v[82:83], v6 offset:59904
    buffer_load_dwordx4 v21, s[12:15], s66 offen offset:1024 lds
    v_subrev_u32 v108, 17, v105
    v_ashrrev_i32 v110, 31, v108
    v_and_b32 v225, v110, v107
    v_bfi_b32 v209, v110, 0, v107
    v_mfma_f32_32x32x16_bf16 v[48:63], v[68:71], a[108:111], v[48:63]
    ds_read_b64_tr_b16 v[84:85], v7 offset:59392
    ds_read_b64_tr_b16 v[86:87], v7 offset:59904
    v_bfi_b32 v106, v111, v109, v110
    v_not_b32 v236, v106
    v_subrev_u32 v108, 18, v105
    v_ashrrev_i32 v109, 31, v108
    s_waitcnt vmcnt(7)
    s_waitcnt lgkmcnt(4)
    v_mfma_f32_32x32x16_bf16 v[32:47], v[72:75], a[112:115], v[32:47]
    ds_read_b64_tr_b16 v[64:65], v6 offset:61440
    ds_read_b64_tr_b16 v[66:67], v6 offset:61952
    v_and_b32 v226, v109, v107
    v_bfi_b32 v210, v109, 0, v107
    v_subrev_u32 v108, 19, v105
    v_mfma_f32_32x32x16_bf16 v[48:63], v[76:79], a[112:115], v[48:63]
    ds_read_b64_tr_b16 v[68:69], v7 offset:61440
    ds_read_b64_tr_b16 v[70:71], v7 offset:61952
    v_ashrrev_i32 v110, 31, v108
    v_and_b32 v227, v110, v107
    v_bfi_b32 v211, v110, 0, v107
    v_bfi_b32 v106, v111, v109, v110
    s_waitcnt vmcnt(6)
    s_waitcnt lgkmcnt(4)
    v_mfma_f32_32x32x16_bf16 v[32:47], v[80:83], a[116:119], v[32:47]
    ds_read_b64_tr_b16 v[72:73], v6 offset:63488
    ds_read_b64_tr_b16 v[74:75], v6 offset:64000
    v_not_b32 v237, v106
    v_subrev_u32 v108, 24, v105
    v_ashrrev_i32 v109, 31, v108
    v_mfma_f32_32x32x16_bf16 v[48:63], v[84:87], a[116:119], v[48:63]
    ds_read_b64_tr_b16 v[76:77], v7 offset:63488
    ds_read_b64_tr_b16 v[78:79], v7 offset:64000
    v_and_b32 v228, v109, v107
    v_bfi_b32 v212, v109, 0, v107
    v_subrev_u32 v108, 25, v105
    v_ashrrev_i32 v110, 31, v108
    s_waitcnt vmcnt(4)
    s_waitcnt lgkmcnt(4)
    v_mfma_f32_32x32x16_bf16 v[32:47], v[64:67], a[120:123], v[32:47]
    v_and_b32 v229, v110, v107
    v_bfi_b32 v213, v110, 0, v107
    v_bfi_b32 v106, v111, v109, v110
    v_not_b32 v238, v106
    v_mfma_f32_32x32x16_bf16 v[48:63], v[68:71], a[120:123], v[48:63]
    v_subrev_u32 v108, 26, v105
    v_ashrrev_i32 v109, 31, v108
    v_and_b32 v230, v109, v107
    s_waitcnt vmcnt(3)
    s_waitcnt lgkmcnt(0)
    v_mfma_f32_32x32x16_bf16 v[32:47], v[72:75], a[124:127], v[32:47]
    v_bfi_b32 v214, v109, 0, v107
    v_subrev_u32 v108, 27, v105
    v_ashrrev_i32 v110, 31, v108
    v_and_b32 v231, v110, v107
    v_mfma_f32_32x32x16_bf16 v[48:63], v[76:79], a[124:127], v[48:63]
    v_bfi_b32 v215, v110, 0, v107
    v_bfi_b32 v106, v111, v109, v110
    v_not_b32 v239, v106
    s_branch L_kvE_23
L_kvV_22:
    s_mov_b32 s64, s46
    ds_read_b64_tr_b16 v[64:65], v6 offset:0
    ds_read_b64_tr_b16 v[66:67], v6 offset:512
    ds_read_b64_tr_b16 v[68:69], v7 offset:0
    ds_read_b64_tr_b16 v[70:71], v7 offset:512
    ds_read_b64_tr_b16 v[72:73], v6 offset:2048
    ds_read_b64_tr_b16 v[74:75], v6 offset:2560
    ds_read_b64_tr_b16 v[76:77], v7 offset:2048
    ds_read_b64_tr_b16 v[78:79], v7 offset:2560
    s_waitcnt vmcnt(9)
    s_waitcnt lgkmcnt(4)
    v_mfma_f32_32x32x16_bf16 v[32:47], a[0:3], v[64:67], 0
    ds_read_b64_tr_b16 v[80:81], v6 offset:4096
    ds_read_b64_tr_b16 v[82:83], v6 offset:4608
    buffer_load_dwordx4 a[40:43], v2, s[40:43], s90 offen offset:2048 sc1
    v_mov_b32 v104, 0x3f803f80
    v_accvgpr_write_b32 a128, v104
    v_accvgpr_write_b32 a129, v104
    v_accvgpr_write_b32 a130, v104
    v_mfma_f32_32x32x16_bf16 v[48:63], a[0:3], v[68:71], 0
    ds_read_b64_tr_b16 v[84:85], v7 offset:4096
    ds_read_b64_tr_b16 v[86:87], v7 offset:4608
    v_accvgpr_write_b32 a131, v104
    v_accvgpr_write_b32 a132, v104
    v_accvgpr_write_b32 a133, v104
    v_accvgpr_write_b32 a134, v104
    s_waitcnt vmcnt(9)
    s_waitcnt lgkmcnt(4)
    v_mfma_f32_32x32x16_bf16 v[32:47], a[4:7], v[72:75], v[32:47]
    ds_read_b64_tr_b16 v[64:65], v6 offset:6144
    ds_read_b64_tr_b16 v[66:67], v6 offset:6656
    buffer_load_dwordx4 a[44:47], v2, s[40:43], s90 offen offset:3072 sc1
    v_accvgpr_write_b32 a135, v104
    v_accvgpr_write_b32 a136, v104
    v_accvgpr_write_b32 a137, v104
    v_mfma_f32_32x32x16_bf16 v[48:63], a[4:7], v[76:79], v[48:63]
    ds_read_b64_tr_b16 v[68:69], v7 offset:6144
    ds_read_b64_tr_b16 v[70:71], v7 offset:6656
    v_accvgpr_write_b32 a138, v104
    v_accvgpr_write_b32 a139, v104
    v_accvgpr_write_b32 a140, v104
    v_accvgpr_write_b32 a141, v104
    s_waitcnt vmcnt(9)
    s_waitcnt lgkmcnt(4)
    v_mfma_f32_32x32x16_bf16 v[32:47], a[8:11], v[80:83], v[32:47]
    ds_read_b64_tr_b16 v[72:73], v6 offset:8192
    ds_read_b64_tr_b16 v[74:75], v6 offset:8704
    s_add_u32 s90, s89, 12288
    buffer_load_dwordx4 a[48:51], v2, s[40:43], s90 offen sc1
    v_accvgpr_write_b32 a142, v104
    v_accvgpr_write_b32 a143, v104
    v_accvgpr_write_b32 a144, v104
    v_accvgpr_write_b32 a145, v104
    v_mfma_f32_32x32x16_bf16 v[48:63], a[8:11], v[84:87], v[48:63]
    ds_read_b64_tr_b16 v[76:77], v7 offset:8192
    ds_read_b64_tr_b16 v[78:79], v7 offset:8704
    v_accvgpr_write_b32 a146, v104
    v_accvgpr_write_b32 a147, v104
    v_accvgpr_write_b32 a148, v104
    s_waitcnt vmcnt(9)
    s_waitcnt lgkmcnt(4)
    v_mfma_f32_32x32x16_bf16 v[32:47], a[12:15], v[64:67], v[32:47]
    ds_read_b64_tr_b16 v[80:81], v6 offset:10240
    ds_read_b64_tr_b16 v[82:83], v6 offset:10752
    buffer_load_dwordx4 a[52:55], v2, s[40:43], s90 offen offset:1024 sc1
    v_accvgpr_write_b32 a149, v104
    v_accvgpr_write_b32 a150, v104
    v_accvgpr_write_b32 a151, v104
    v_accvgpr_write_b32 a152, v104
    v_mfma_f32_32x32x16_bf16 v[48:63], a[12:15], v[68:71], v[48:63]
    ds_read_b64_tr_b16 v[84:85], v7 offset:10240
    ds_read_b64_tr_b16 v[86:87], v7 offset:10752
    v_accvgpr_write_b32 a153, v104
    v_accvgpr_write_b32 a154, v104
    v_accvgpr_write_b32 a155, v104
    s_waitcnt vmcnt(9)
    s_waitcnt lgkmcnt(4)
    v_mfma_f32_32x32x16_bf16 v[32:47], a[16:19], v[72:75], v[32:47]
    ds_read_b64_tr_b16 v[64:65], v6 offset:12288
    ds_read_b64_tr_b16 v[66:67], v6 offset:12800
    buffer_load_dwordx4 a[56:59], v2, s[40:43], s90 offen offset:2048 sc1
    v_accvgpr_write_b32 a156, v104
    v_accvgpr_write_b32 a157, v104
    v_accvgpr_write_b32 a158, v104
    v_accvgpr_write_b32 a159, v104
    v_mfma_f32_32x32x16_bf16 v[48:63], a[16:19], v[76:79], v[48:63]
    ds_read_b64_tr_b16 v[68:69], v7 offset:12288
    ds_read_b64_tr_b16 v[70:71], v7 offset:12800
    v_accvgpr_write_b32 a160, v104
    v_accvgpr_write_b32 a161, v104
    v_accvgpr_write_b32 a162, v104
    v_accvgpr_write_b32 a163, v104
    s_waitcnt vmcnt(9)
    s_waitcnt lgkmcnt(4)
    v_mfma_f32_32x32x16_bf16 v[32:47], a[20:23], v[80:83], v[32:47]
    ds_read_b64_tr_b16 v[72:73], v6 offset:14336
    ds_read_b64_tr_b16 v[74:75], v6 offset:14848
    buffer_load_dwordx4 a[60:63], v2, s[40:43], s90 offen offset:3072 sc1
    v_accvgpr_write_b32 a164, v104
    v_accvgpr_write_b32 a165, v104
    v_accvgpr_write_b32 a166, v104
    v_mfma_f32_32x32x16_bf16 v[48:63], a[20:23], v[84:87], v[48:63]
    ds_read_b64_tr_b16 v[76:77], v7 offset:14336
    ds_read_b64_tr_b16 v[78:79], v7 offset:14848
    v_accvgpr_write_b32 a167, v104
    v_accvgpr_write_b32 a168, v104
    v_accvgpr_write_b32 a169, v104
    v_accvgpr_write_b32 a170, v104
    s_waitcnt vmcnt(9)
    s_waitcnt lgkmcnt(4)
    v_mfma_f32_32x32x16_bf16 v[32:47], a[24:27], v[64:67], v[32:47]
    ds_read_b64_tr_b16 v[80:81], v6 offset:16384
    ds_read_b64_tr_b16 v[82:83], v6 offset:16896
    s_add_u32 s90, s89, 16384
    buffer_load_dwordx4 a[64:67], v2, s[40:43], s90 offen sc1
    v_accvgpr_write_b32 a171, v104
    v_accvgpr_write_b32 a172, v104
    v_accvgpr_write_b32 a173, v104
    v_mfma_f32_32x32x16_bf16 v[48:63], a[24:27], v[68:71], v[48:63]
    ds_read_b64_tr_b16 v[84:85], v7 offset:16384
    ds_read_b64_tr_b16 v[86:87], v7 offset:16896
    v_accvgpr_write_b32 a174, v104
    v_accvgpr_write_b32 a175, v104
    v_accvgpr_write_b32 a176, v104
    v_accvgpr_write_b32 a177, v104
    s_waitcnt vmcnt(9)
    s_waitcnt lgkmcnt(4)
    v_mfma_f32_32x32x16_bf16 v[32:47], a[28:31], v[72:75], v[32:47]
    ds_read_b64_tr_b16 v[64:65], v6 offset:18432
    ds_read_b64_tr_b16 v[66:67], v6 offset:18944
    buffer_load_dwordx4 a[68:71], v2, s[40:43], s90 offen offset:1024 sc1
    v_accvgpr_write_b32 a178, v104
    v_accvgpr_write_b32 a179, v104
    v_accvgpr_write_b32 a180, v104
    v_accvgpr_write_b32 a181, v104
    v_mfma_f32_32x32x16_bf16 v[48:63], a[28:31], v[76:79], v[48:63]
    ds_read_b64_tr_b16 v[68:69], v7 offset:18432
    ds_read_b64_tr_b16 v[70:71], v7 offset:18944
    v_accvgpr_write_b32 a182, v104
    v_accvgpr_write_b32 a183, v104
    v_accvgpr_write_b32 a184, v104
    s_waitcnt vmcnt(9)
    s_waitcnt lgkmcnt(4)
    v_mfma_f32_32x32x16_bf16 v[32:47], a[32:35], v[80:83], v[32:47]
    ds_read_b64_tr_b16 v[72:73], v6 offset:20480
    ds_read_b64_tr_b16 v[74:75], v6 offset:20992
    buffer_load_dwordx4 a[72:75], v2, s[40:43], s90 offen offset:2048 sc1
    v_accvgpr_write_b32 a185, v104
    v_accvgpr_write_b32 a186, v104
    v_accvgpr_write_b32 a187, v104
    v_accvgpr_write_b32 a188, v104
    v_mfma_f32_32x32x16_bf16 v[48:63], a[32:35], v[84:87], v[48:63]
    ds_read_b64_tr_b16 v[76:77], v7 offset:20480
    ds_read_b64_tr_b16 v[78:79], v7 offset:20992
    v_accvgpr_write_b32 a189, v104
    v_accvgpr_write_b32 a190, v104
    v_accvgpr_write_b32 a191, v104
    s_waitcnt vmcnt(9)
    s_waitcnt lgkmcnt(4)
    v_mfma_f32_32x32x16_bf16 v[32:47], a[36:39], v[64:67], v[32:47]
    ds_read_b64_tr_b16 v[80:81], v6 offset:22528
    ds_read_b64_tr_b16 v[82:83], v6 offset:23040
    buffer_load_dwordx4 a[76:79], v2, s[40:43], s90 offen offset:3072 sc1
    v_accvgpr_write_b32 a192, v104
    v_accvgpr_write_b32 a193, v104
    v_accvgpr_write_b32 a194, v104
    v_accvgpr_write_b32 a195, v104
    v_mfma_f32_32x32x16_bf16 v[48:63], a[36:39], v[68:71], v[48:63]
    ds_read_b64_tr_b16 v[84:85], v7 offset:22528
    ds_read_b64_tr_b16 v[86:87], v7 offset:23040
    s_mul_i32 s56, s64, 4
    s_mul_i32 s57, s82, 3
    s_add_u32 s56, s56, s57
    s_mul_i32 s84, s83, 2048
    s_mul_i32 s85, s83, 98304
    s_mul_i32 s57, s97, 2
    s_mul_i32 s57, s57, s83
    s_add_u32 s56, s56, s57
    s_mul_i32 s95, s97, 4
    s_mul_i32 s95, s95, s83
    s_mul_i32 s65, s56, 2048
    s_add_u32 s65, s65, 65536
    s_mul_i32 s66, s56, 98304
    s_add_u32 s66, s66, s86
    s_mov_b32 m0, s65
    s_nop 0
    buffer_load_dwordx4 v3, s[12:15], s66 offen lds
    v_accvgpr_write_b32 a196, v104
    v_accvgpr_write_b32 a197, v104
    v_accvgpr_write_b32 a198, v104
    v_accvgpr_write_b32 a199, v104
    s_waitcnt vmcnt(10)
    s_waitcnt lgkmcnt(4)
    v_mfma_f32_32x32x16_bf16 v[32:47], a[40:43], v[72:75], v[32:47]
    ds_read_b64_tr_b16 v[64:65], v6 offset:24576
    ds_read_b64_tr_b16 v[66:67], v6 offset:25088
    s_add_u32 s90, s89, 20480
    buffer_load_dwordx4 a[80:83], v2, s[40:43], s90 offen sc1
    v_accvgpr_write_b32 a200, v104
    v_accvgpr_write_b32 a201, v104
    v_accvgpr_write_b32 a202, v104
    v_mfma_f32_32x32x16_bf16 v[48:63], a[40:43], v[76:79], v[48:63]
    ds_read_b64_tr_b16 v[68:69], v7 offset:24576
    ds_read_b64_tr_b16 v[70:71], v7 offset:25088
    v_accvgpr_write_b32 a203, v104
    v_accvgpr_write_b32 a204, v104
    v_accvgpr_write_b32 a205, v104
    v_accvgpr_write_b32 a206, v104
    s_waitcnt vmcnt(10)
    s_waitcnt lgkmcnt(4)
    v_mfma_f32_32x32x16_bf16 v[32:47], a[44:47], v[80:83], v[32:47]
    ds_read_b64_tr_b16 v[72:73], v6 offset:26624
    ds_read_b64_tr_b16 v[74:75], v6 offset:27136
    buffer_load_dwordx4 a[84:87], v2, s[40:43], s90 offen offset:1024 sc1
    v_accvgpr_write_b32 a207, v104
    v_accvgpr_write_b32 a208, v104
    v_accvgpr_write_b32 a209, v104
    v_accvgpr_write_b32 a210, v104
    v_mfma_f32_32x32x16_bf16 v[48:63], a[44:47], v[84:87], v[48:63]
    ds_read_b64_tr_b16 v[76:77], v7 offset:26624
    ds_read_b64_tr_b16 v[78:79], v7 offset:27136
    v_accvgpr_write_b32 a211, v104
    v_accvgpr_write_b32 a212, v104
    v_accvgpr_write_b32 a213, v104
    s_waitcnt vmcnt(10)
    s_waitcnt lgkmcnt(4)
    v_mfma_f32_32x32x16_bf16 v[32:47], a[48:51], v[64:67], v[32:47]
    ds_read_b64_tr_b16 v[80:81], v6 offset:28672
    ds_read_b64_tr_b16 v[82:83], v6 offset:29184
    buffer_load_dwordx4 a[88:91], v2, s[40:43], s90 offen offset:2048 sc1
    buffer_load_dwordx4 v21, s[12:15], s66 offen offset:1024 lds
    s_add_u32 s65, s65, s84
    s_add_u32 s66, s66, s85
    s_mov_b32 m0, s65
    v_accvgpr_write_b32 a214, v104
    v_accvgpr_write_b32 a215, v104
    v_accvgpr_write_b32 a216, v104
    v_accvgpr_write_b32 a217, v104
    v_mfma_f32_32x32x16_bf16 v[48:63], a[48:51], v[68:71], v[48:63]
    ds_read_b64_tr_b16 v[84:85], v7 offset:28672
    ds_read_b64_tr_b16 v[86:87], v7 offset:29184
    v_accvgpr_write_b32 a218, v104
    v_accvgpr_write_b32 a219, v104
    v_accvgpr_write_b32 a220, v104
    s_waitcnt vmcnt(11)
    s_waitcnt lgkmcnt(4)
    v_mfma_f32_32x32x16_bf16 v[32:47], a[52:55], v[72:75], v[32:47]
    ds_read_b64_tr_b16 v[64:65], v6 offset:30720
    ds_read_b64_tr_b16 v[66:67], v6 offset:31232
    buffer_load_dwordx4 a[92:95], v2, s[40:43], s90 offen offset:3072 sc1
    v_accvgpr_write_b32 a221, v104
    v_accvgpr_write_b32 a222, v104
    v_accvgpr_write_b32 a223, v104
    v_accvgpr_write_b32 a224, v104
    v_mfma_f32_32x32x16_bf16 v[48:63], a[52:55], v[76:79], v[48:63]
    ds_read_b64_tr_b16 v[68:69], v7 offset:30720
    ds_read_b64_tr_b16 v[70:71], v7 offset:31232
    v_accvgpr_write_b32 a225, v104
    v_accvgpr_write_b32 a226, v104
    v_accvgpr_write_b32 a227, v104
    v_accvgpr_write_b32 a228, v104
    s_waitcnt vmcnt(11)
    s_waitcnt lgkmcnt(4)
    v_mfma_f32_32x32x16_bf16 v[32:47], a[56:59], v[80:83], v[32:47]
    ds_read_b64_tr_b16 v[72:73], v6 offset:32768
    ds_read_b64_tr_b16 v[74:75], v6 offset:33280
    s_add_u32 s90, s89, 24576
    buffer_load_dwordx4 a[96:99], v2, s[40:43], s90 offen sc1
    v_accvgpr_write_b32 a229, v104
    v_accvgpr_write_b32 a230, v104
    v_accvgpr_write_b32 a231, v104
    v_mfma_f32_32x32x16_bf16 v[48:63], a[56:59], v[84:87], v[48:63]
    ds_read_b64_tr_b16 v[76:77], v7 offset:32768
    ds_read_b64_tr_b16 v[78:79], v7 offset:33280
    buffer_load_dwordx4 v3, s[12:15], s66 offen lds
    v_accvgpr_write_b32 a232, v104
    v_accvgpr_write_b32 a233, v104
    v_accvgpr_write_b32 a234, v104
    v_accvgpr_write_b32 a235, v104
    s_waitcnt vmcnt(12)
    s_waitcnt lgkmcnt(4)
    v_mfma_f32_32x32x16_bf16 v[32:47], a[60:63], v[64:67], v[32:47]
    ds_read_b64_tr_b16 v[80:81], v6 offset:34816
    ds_read_b64_tr_b16 v[82:83], v6 offset:35328
    buffer_load_dwordx4 a[100:103], v2, s[40:43], s90 offen offset:1024 sc1
    v_accvgpr_write_b32 a236, v104
    v_accvgpr_write_b32 a237, v104
    v_accvgpr_write_b32 a238, v104
    v_mfma_f32_32x32x16_bf16 v[48:63], a[60:63], v[68:71], v[48:63]
    ds_read_b64_tr_b16 v[84:85], v7 offset:34816
    ds_read_b64_tr_b16 v[86:87], v7 offset:35328
    v_accvgpr_write_b32 a239, v104
    v_accvgpr_write_b32 a240, v104
    v_accvgpr_write_b32 a241, v104
    v_accvgpr_write_b32 a242, v104
    s_waitcnt vmcnt(12)
    s_waitcnt lgkmcnt(4)
    v_mfma_f32_32x32x16_bf16 v[32:47], a[64:67], v[72:75], v[32:47]
    ds_read_b64_tr_b16 v[64:65], v6 offset:36864
    ds_read_b64_tr_b16 v[66:67], v6 offset:37376
    buffer_load_dwordx4 a[104:107], v2, s[40:43], s90 offen offset:2048 sc1
    v_accvgpr_write_b32 a243, v104
    v_accvgpr_write_b32 a244, v104
    v_accvgpr_write_b32 a245, v104
    v_accvgpr_write_b32 a246, v104
    v_mfma_f32_32x32x16_bf16 v[48:63], a[64:67], v[76:79], v[48:63]
    ds_read_b64_tr_b16 v[68:69], v7 offset:36864
    ds_read_b64_tr_b16 v[70:71], v7 offset:37376
    v_accvgpr_write_b32 a247, v104
    v_accvgpr_write_b32 a248, v104
    v_accvgpr_write_b32 a249, v104
    s_waitcnt vmcnt(12)
    s_waitcnt lgkmcnt(4)
    v_mfma_f32_32x32x16_bf16 v[32:47], a[68:71], v[80:83], v[32:47]
    ds_read_b64_tr_b16 v[72:73], v6 offset:38912
    ds_read_b64_tr_b16 v[74:75], v6 offset:39424
    buffer_load_dwordx4 a[108:111], v2, s[40:43], s90 offen offset:3072 sc1
    buffer_load_dwordx4 v21, s[12:15], s66 offen offset:1024 lds
    s_sub_u32 s56, s83, s95
    s_mul_i32 s57, s56, 2048
    s_add_u32 s65, s65, s57
    s_mul_i32 s57, s56, 98304
    s_add_u32 s66, s66, s57
    s_mov_b32 m0, s65
    v_accvgpr_write_b32 a250, v104
    v_accvgpr_write_b32 a251, v104
    v_accvgpr_write_b32 a252, v104
    v_accvgpr_write_b32 a253, v104
    v_mfma_f32_32x32x16_bf16 v[48:63], a[68:71], v[84:87], v[48:63]
    ds_read_b64_tr_b16 v[76:77], v7 offset:38912
    ds_read_b64_tr_b16 v[78:79], v7 offset:39424
    v_accvgpr_write_b32 a254, v104
    v_accvgpr_write_b32 a255, v104
    v_mov_b32 v240, v104
    s_waitcnt vmcnt(13)
    s_waitcnt lgkmcnt(4)
    v_mfma_f32_32x32x16_bf16 v[32:47], a[72:75], v[64:67], v[32:47]
    ds_read_b64_tr_b16 v[80:81], v6 offset:40960
    ds_read_b64_tr_b16 v[82:83], v6 offset:41472
    s_add_u32 s90, s89, 28672
    buffer_load_dwordx4 a[112:115], v2, s[40:43], s90 offen sc1
    v_mov_b32 v241, v104
    v_mov_b32 v242, v104
    v_mov_b32 v243, v104
    v_mov_b32 v244, v104
    v_mfma_f32_32x32x16_bf16 v[48:63], a[72:75], v[68:71], v[48:63]
    ds_read_b64_tr_b16 v[84:85], v7 offset:40960
    ds_read_b64_tr_b16 v[86:87], v7 offset:41472
    v_mov_b32 v245, v104
    v_mov_b32 v246, v104
    v_mov_b32 v247, v104
    v_mov_b32 v248, v104
    s_waitcnt vmcnt(13)
    s_waitcnt lgkmcnt(4)
    v_mfma_f32_32x32x16_bf16 v[32:47], a[76:79], v[72:75], v[32:47]
    ds_read_b64_tr_b16 v[64:65], v6 offset:43008
    ds_read_b64_tr_b16 v[66:67], v6 offset:43520
    buffer_load_dwordx4 a[116:119], v2, s[40:43], s90 offen offset:1024 sc1
    v_mov_b32 v249, v104
    v_mov_b32 v250, v104
    v_mov_b32 v251, v104
    v_mfma_f32_32x32x16_bf16 v[48:63], a[76:79], v[76:79], v[48:63]
    ds_read_b64_tr_b16 v[68:69], v7 offset:43008
    ds_read_b64_tr_b16 v[70:71], v7 offset:43520
    buffer_load_dwordx4 v3, s[12:15], s66 offen lds
    v_mov_b32 v252, v104
    v_mov_b32 v253, v104
    v_mov_b32 v254, v104
    v_mov_b32 v255, v104
    s_waitcnt vmcnt(13)
    s_waitcnt lgkmcnt(4)
    v_mfma_f32_32x32x16_bf16 v[32:47], a[80:83], v[80:83], v[32:47]
    ds_read_b64_tr_b16 v[72:73], v6 offset:45056
    ds_read_b64_tr_b16 v[74:75], v6 offset:45568
    buffer_load_dwordx4 a[120:123], v2, s[40:43], s90 offen offset:2048 sc1
    v_and_b32 v105, 31, v1
    v_lshrrev_b32 v106, 5, v1
    v_lshlrev_b32 v106, 2, v106
    v_mfma_f32_32x32x16_bf16 v[48:63], a[80:83], v[84:87], v[48:63]
    ds_read_b64_tr_b16 v[76:77], v7 offset:45056
    ds_read_b64_tr_b16 v[78:79], v7 offset:45568
    v_sub_u32 v105, v105, v106
    v_mov_b32 v107, 0xf149f2ca
    v_mov_b32 v111, 0xffff
    v_subrev_u32 v108, 0, v105
    s_waitcnt vmcnt(13)
    s_waitcnt lgkmcnt(4)
    v_mfma_f32_32x32x16_bf16 v[32:47], a[84:87], v[64:67], v[32:47]
    ds_read_b64_tr_b16 v[80:81], v6 offset:47104
    ds_read_b64_tr_b16 v[82:83], v6 offset:47616
    buffer_load_dwordx4 a[124:127], v2, s[40:43], s90 offen offset:3072 sc1
    v_ashrrev_i32 v109, 31, v108
    v_and_b32 v216, v109, v107
    v_bfi_b32 v200, v109, 0, v107
    v_subrev_u32 v108, 1, v105
    v_mfma_f32_32x32x16_bf16 v[48:63], a[84:87], v[68:71], v[48:63]
    ds_read_b64_tr_b16 v[84:85], v7 offset:47104
    ds_read_b64_tr_b16 v[86:87], v7 offset:47616
    v_ashrrev_i32 v110, 31, v108
    v_and_b32 v217, v110, v107
    v_bfi_b32 v201, v110, 0, v107
    s_waitcnt vmcnt(13)
    s_waitcnt lgkmcnt(4)
    v_mfma_f32_32x32x16_bf16 v[32:47], a[88:91], v[72:75], v[32:47]
    ds_read_b64_tr_b16 v[64:65], v6 offset:49152
    ds_read_b64_tr_b16 v[66:67], v6 offset:49664
    buffer_load_dwordx4 v21, s[12:15], s66 offen offset:1024 lds
    s_add_u32 s65, s65, s84
    s_add_u32 s66, s66, s85
    s_mov_b32 m0, s65
    v_bfi_b32 v106, v111, v109, v110
    v_not_b32 v232, v106
    v_subrev_u32 v108, 2, v105
    v_ashrrev_i32 v109, 31, v108
    v_mfma_f32_32x32x16_bf16 v[48:63], a[88:91], v[76:79], v[48:63]
    ds_read_b64_tr_b16 v[68:69], v7 offset:49152
    ds_read_b64_tr_b16 v[70:71], v7 offset:49664
    v_and_b32 v218, v109, v107
    v_bfi_b32 v202, v109, 0, v107
    v_subrev_u32 v108, 3, v105
    v_ashrrev_i32 v110, 31, v108
    s_waitcnt vmcnt(12)
    s_waitcnt lgkmcnt(4)
    v_mfma_f32_32x32x16_bf16 v[32:47], a[92:95], v[80:83], v[32:47]
    ds_read_b64_tr_b16 v[72:73], v6 offset:51200
    ds_read_b64_tr_b16 v[74:75], v6 offset:51712
    v_and_b32 v219, v110, v107
    v_bfi_b32 v203, v110, 0, v107
    v_bfi_b32 v106, v111, v109, v110
    v_mfma_f32_32x32x16_bf16 v[48:63], a[92:95], v[84:87], v[48:63]
    ds_read_b64_tr_b16 v[76:77], v7 offset:51200
    ds_read_b64_tr_b16 v[78:79], v7 offset:51712
    v_not_b32 v233, v106
    v_subrev_u32 v108, 8, v105
    v_ashrrev_i32 v109, 31, v108
    v_and_b32 v220, v109, v107
    s_waitcnt vmcnt(11)
    s_waitcnt lgkmcnt(4)
    v_mfma_f32_32x32x16_bf16 v[32:47], a[96:99], v[64:67], v[32:47]
    ds_read_b64_tr_b16 v[80:81], v6 offset:53248
    ds_read_b64_tr_b16 v[82:83], v6 offset:53760
    v_bfi_b32 v204, v109, 0, v107
    v_subrev_u32 v108, 9, v105
    v_ashrrev_i32 v110, 31, v108
    v_mfma_f32_32x32x16_bf16 v[48:63], a[96:99], v[68:71], v[48:63]
    ds_read_b64_tr_b16 v[84:85], v7 offset:53248
    ds_read_b64_tr_b16 v[86:87], v7 offset:53760
    buffer_load_dwordx4 v3, s[12:15], s66 offen lds
    v_and_b32 v221, v110, v107
    v_bfi_b32 v205, v110, 0, v107
    v_bfi_b32 v106, v111, v109, v110
    v_not_b32 v234, v106
    s_waitcnt vmcnt(10)
    s_waitcnt lgkmcnt(4)
    v_mfma_f32_32x32x16_bf16 v[32:47], a[100:103], v[72:75], v[32:47]
    ds_read_b64_tr_b16 v[64:65], v6 offset:55296
    ds_read_b64_tr_b16 v[66:67], v6 offset:55808
    v_subrev_u32 v108, 10, v105
    v_ashrrev_i32 v109, 31, v108
    v_and_b32 v222, v109, v107
    v_bfi_b32 v206, v109, 0, v107
    v_mfma_f32_32x32x16_bf16 v[48:63], a[100:103], v[76:79], v[48:63]
    ds_read_b64_tr_b16 v[68:69], v7 offset:55296
    ds_read_b64_tr_b16 v[70:71], v7 offset:55808
    v_subrev_u32 v108, 11, v105
    v_ashrrev_i32 v110, 31, v108
    v_and_b32 v223, v110, v107
    s_waitcnt vmcnt(9)
    s_waitcnt lgkmcnt(4)
    v_mfma_f32_32x32x16_bf16 v[32:47], a[104:107], v[80:83], v[32:47]
    ds_read_b64_tr_b16 v[72:73], v6 offset:57344
    ds_read_b64_tr_b16 v[74:75], v6 offset:57856
    v_bfi_b32 v207, v110, 0, v107
    v_bfi_b32 v106, v111, v109, v110
    v_not_b32 v235, v106
    v_subrev_u32 v108, 16, v105
    v_mfma_f32_32x32x16_bf16 v[48:63], a[104:107], v[84:87], v[48:63]
    ds_read_b64_tr_b16 v[76:77], v7 offset:57344
    ds_read_b64_tr_b16 v[78:79], v7 offset:57856
    v_ashrrev_i32 v109, 31, v108
    v_and_b32 v224, v109, v107
    v_bfi_b32 v208, v109, 0, v107
    s_waitcnt vmcnt(8)
    s_waitcnt lgkmcnt(4)
    v_mfma_f32_32x32x16_bf16 v[32:47], a[108:111], v[64:67], v[32:47]
    ds_read_b64_tr_b16 v[80:81], v6 offset:59392
    ds_read_b64_tr_b16 v[82:83], v6 offset:59904
    buffer_load_dwordx4 v21, s[12:15], s66 offen offset:1024 lds
    v_subrev_u32 v108, 17, v105
    v_ashrrev_i32 v110, 31, v108
    v_and_b32 v225, v110, v107
    v_bfi_b32 v209, v110, 0, v107
    v_mfma_f32_32x32x16_bf16 v[48:63], a[108:111], v[68:71], v[48:63]
    ds_read_b64_tr_b16 v[84:85], v7 offset:59392
    ds_read_b64_tr_b16 v[86:87], v7 offset:59904
    v_bfi_b32 v106, v111, v109, v110
    v_not_b32 v236, v106
    v_subrev_u32 v108, 18, v105
    v_ashrrev_i32 v109, 31, v108
    s_waitcnt vmcnt(7)
    s_waitcnt lgkmcnt(4)
    v_mfma_f32_32x32x16_bf16 v[32:47], a[112:115], v[72:75], v[32:47]
    ds_read_b64_tr_b16 v[64:65], v6 offset:61440
    ds_read_b64_tr_b16 v[66:67], v6 offset:61952
    v_and_b32 v226, v109, v107
    v_bfi_b32 v210, v109, 0, v107
    v_subrev_u32 v108, 19, v105
    v_mfma_f32_32x32x16_bf16 v[48:63], a[112:115], v[76:79], v[48:63]
    ds_read_b64_tr_b16 v[68:69], v7 offset:61440
    ds_read_b64_tr_b16 v[70:71], v7 offset:61952
    v_ashrrev_i32 v110, 31, v108
    v_and_b32 v227, v110, v107
    v_bfi_b32 v211, v110, 0, v107
    v_bfi_b32 v106, v111, v109, v110
    s_waitcnt vmcnt(6)
    s_waitcnt lgkmcnt(4)
    v_mfma_f32_32x32x16_bf16 v[32:47], a[116:119], v[80:83], v[32:47]
    ds_read_b64_tr_b16 v[72:73], v6 offset:63488
    ds_read_b64_tr_b16 v[74:75], v6 offset:64000
    v_not_b32 v237, v106
    v_subrev_u32 v108, 24, v105
    v_ashrrev_i32 v109, 31, v108
    v_mfma_f32_32x32x16_bf16 v[48:63], a[116:119], v[84:87], v[48:63]
    ds_read_b64_tr_b16 v[76:77], v7 offset:63488
    ds_read_b64_tr_b16 v[78:79], v7 offset:64000
    v_and_b32 v228, v109, v107
    v_bfi_b32 v212, v109, 0, v107
    v_subrev_u32 v108, 25, v105
    v_ashrrev_i32 v110, 31, v108
    s_waitcnt vmcnt(4)
    s_waitcnt lgkmcnt(4)
    v_mfma_f32_32x32x16_bf16 v[32:47], a[120:123], v[64:67], v[32:47]
    v_and_b32 v229, v110, v107
    v_bfi_b32 v213, v110, 0, v107
    v_bfi_b32 v106, v111, v109, v110
    v_not_b32 v238, v106
    v_mfma_f32_32x32x16_bf16 v[48:63], a[120:123], v[68:71], v[48:63]
    v_subrev_u32 v108, 26, v105
    v_ashrrev_i32 v109, 31, v108
    v_and_b32 v230, v109, v107
    s_waitcnt vmcnt(3)
    s_waitcnt lgkmcnt(0)
    v_mfma_f32_32x32x16_bf16 v[32:47], a[124:127], v[72:75], v[32:47]
    v_bfi_b32 v214, v109, 0, v107
    v_subrev_u32 v108, 27, v105
    v_ashrrev_i32 v110, 31, v108
    v_and_b32 v231, v110, v107
    v_mfma_f32_32x32x16_bf16 v[48:63], a[124:127], v[76:79], v[48:63]
    v_bfi_b32 v215, v110, 0, v107
    v_bfi_b32 v106, v111, v109, v110
    v_not_b32 v239, v106
L_kvE_23:
    s_waitcnt vmcnt(0)
    s_barrier
    s_nop 1
    v_cvt_pk_bf16_f32 v112, v32, v33
    v_cvt_pk_bf16_f32 v113, v34, v35
    v_cvt_pk_bf16_f32 v114, v36, v37
    v_cvt_pk_bf16_f32 v115, v38, v39
    v_cvt_pk_bf16_f32 v116, v40, v41
    v_cvt_pk_bf16_f32 v117, v42, v43
    v_cvt_pk_bf16_f32 v118, v44, v45
    v_cvt_pk_bf16_f32 v119, v46, v47
    v_cvt_pk_bf16_f32 v120, v48, v49
    v_cvt_pk_bf16_f32 v121, v50, v51
    v_cvt_pk_bf16_f32 v122, v52, v53
    v_cvt_pk_bf16_f32 v123, v54, v55
    v_cvt_pk_bf16_f32 v124, v56, v57
    v_cvt_pk_bf16_f32 v125, v58, v59
    v_cvt_pk_bf16_f32 v126, v60, v61
    v_cvt_pk_bf16_f32 v127, v62, v63
    s_cmp_ge_u32 s45, 8
    s_cselect_b32 s60, 2097152, 0
    s_add_u32 s60, s60, 4194304
    s_lshl_b32 s59, s47, 15
    s_add_u32 s60, s60, s59
    s_and_b32 s59, s45, 7
    s_lshl_b32 s59, s59, 12
    s_add_u32 s60, s60, s59
    buffer_store_dwordx4 v[112:115], v2, s[40:43], s60 offen sc1
    buffer_store_dwordx4 v[116:119], v2, s[40:43], s60 offen offset:1024 sc1
    buffer_store_dwordx4 v[120:123], v2, s[40:43], s60 offen offset:2048 sc1
    buffer_store_dwordx4 v[124:127], v2, s[40:43], s60 offen offset:3072 sc1
    v_lshrrev_b32 v12, 5, v1
    v_lshlrev_b32 v12, 3, v12
    v_bfe_u32 v13, v1, 2, 2
    v_add_u32 v12, v12, v13
    v_lshlrev_b32 v12, 6, v12
    v_bfe_u32 v13, v1, 4, 1
    v_lshl_add_u32 v12, v13, 5, v12
    v_and_b32 v13, 3, v1
    v_lshl_add_u32 v8, v13, 3, v12
    v_add_u32 v8, 65536, v8
    v_and_b32 v12, 31, v1
    v_lshrrev_b32 v13, 5, v1
    v_lshlrev_b32 v12, 10, v12
    v_lshl_add_u32 v10, v13, 4, v12
    s_lshl_b32 s57, s51, 15
    s_lshl_b32 s58, s54, 6
    s_add_u32 s91, s57, s58
    s_mov_b32 s64, s46
    ds_read_b64_tr_b16 v[64:65], v8 offset:0
    ds_read_b64_tr_b16 v[66:67], v8 offset:256
    ds_read_b64_tr_b16 v[68:69], v8 offset:1024
    ds_read_b64_tr_b16 v[70:71], v8 offset:1280
    s_waitcnt lgkmcnt(2)
    v_mfma_f32_32x32x16_bf16 v[96:111], v[64:67], a[0:3], 0
    ds_read_b64_tr_b16 v[72:73], v8 offset:2048
    ds_read_b64_tr_b16 v[74:75], v8 offset:2304
    s_mul_i32 s56, s64, 4
    s_mul_i32 s57, s82, 3
    s_add_u32 s56, s56, s57
    s_mul_i32 s84, s83, 3072
    s_mul_i32 s85, s83, 44032
    s_mul_i32 s65, s56, 3072
    s_mul_i32 s66, s56, 44032
    s_add_u32 s66, s66, s88
    s_mov_b32 m0, s65
    s_nop 0
    buffer_load_dwordx4 v4, s[24:27], s66 offen lds
    s_waitcnt lgkmcnt(2)
    v_mfma_f32_32x32x16_bf16 v[96:111], v[68:71], a[4:7], v[96:111]
    ds_read_b64_tr_b16 v[64:65], v8 offset:3072
    ds_read_b64_tr_b16 v[66:67], v8 offset:3328
    s_waitcnt lgkmcnt(2)
    v_mfma_f32_32x32x16_bf16 v[96:111], v[72:75], a[8:11], v[96:111]
    ds_read_b64_tr_b16 v[68:69], v8 offset:4096
    ds_read_b64_tr_b16 v[70:71], v8 offset:4352
    s_waitcnt lgkmcnt(2)
    v_mfma_f32_32x32x16_bf16 v[96:111], v[64:67], a[12:15], v[96:111]
    ds_read_b64_tr_b16 v[72:73], v8 offset:5120
    ds_read_b64_tr_b16 v[74:75], v8 offset:5376
    s_waitcnt lgkmcnt(2)
    v_mfma_f32_32x32x16_bf16 v[96:111], v[68:71], a[16:19], v[96:111]
    ds_read_b64_tr_b16 v[64:65], v8 offset:6144
    ds_read_b64_tr_b16 v[66:67], v8 offset:6400
    s_waitcnt lgkmcnt(2)
    v_mfma_f32_32x32x16_bf16 v[96:111], v[72:75], a[20:23], v[96:111]
    ds_read_b64_tr_b16 v[68:69], v8 offset:7168
    ds_read_b64_tr_b16 v[70:71], v8 offset:7424
    buffer_load_dwordx4 v24, s[24:27], s66 offen offset:1024 lds
    s_waitcnt lgkmcnt(2)
    v_mfma_f32_32x32x16_bf16 v[96:111], v[64:67], a[24:27], v[96:111]
    ds_read_b64_tr_b16 v[72:73], v8 offset:8192
    ds_read_b64_tr_b16 v[74:75], v8 offset:8448
    s_waitcnt lgkmcnt(2)
    v_mfma_f32_32x32x16_bf16 v[96:111], v[68:71], a[28:31], v[96:111]
    ds_read_b64_tr_b16 v[64:65], v8 offset:9216
    ds_read_b64_tr_b16 v[66:67], v8 offset:9472
    s_waitcnt lgkmcnt(2)
    v_mfma_f32_32x32x16_bf16 v[96:111], v[72:75], a[32:35], v[96:111]
    ds_read_b64_tr_b16 v[68:69], v8 offset:10240
    ds_read_b64_tr_b16 v[70:71], v8 offset:10496
    s_waitcnt lgkmcnt(2)
    v_mfma_f32_32x32x16_bf16 v[96:111], v[64:67], a[36:39], v[96:111]
    ds_read_b64_tr_b16 v[72:73], v8 offset:11264
    ds_read_b64_tr_b16 v[74:75], v8 offset:11520
    s_waitcnt lgkmcnt(2)
    v_mfma_f32_32x32x16_bf16 v[96:111], v[68:71], a[40:43], v[96:111]
    ds_read_b64_tr_b16 v[64:65], v8 offset:12288
    ds_read_b64_tr_b16 v[66:67], v8 offset:12544
    buffer_load_dwordx4 v25, s[24:27], s66 offen offset:2048 lds
    s_add_u32 s65, s65, s84
    s_add_u32 s66, s66, s85
    s_mov_b32 m0, s65
    s_waitcnt lgkmcnt(2)
    v_mfma_f32_32x32x16_bf16 v[96:111], v[72:75], a[44:47], v[96:111]
    ds_read_b64_tr_b16 v[68:69], v8 offset:13312
    ds_read_b64_tr_b16 v[70:71], v8 offset:13568
    s_waitcnt lgkmcnt(2)
    v_mfma_f32_32x32x16_bf16 v[96:111], v[64:67], a[48:51], v[96:111]
    ds_read_b64_tr_b16 v[72:73], v8 offset:14336
    ds_read_b64_tr_b16 v[74:75], v8 offset:14592
    s_waitcnt lgkmcnt(2)
    v_mfma_f32_32x32x16_bf16 v[96:111], v[68:71], a[52:55], v[96:111]
    ds_read_b64_tr_b16 v[64:65], v8 offset:15360
    ds_read_b64_tr_b16 v[66:67], v8 offset:15616
    s_waitcnt lgkmcnt(2)
    v_mfma_f32_32x32x16_bf16 v[96:111], v[72:75], a[56:59], v[96:111]
    ds_read_b64_tr_b16 v[68:69], v8 offset:16384
    ds_read_b64_tr_b16 v[70:71], v8 offset:16640
    s_waitcnt lgkmcnt(2)
    v_mfma_f32_32x32x16_bf16 v[96:111], v[64:67], a[60:63], v[96:111]
    ds_read_b64_tr_b16 v[72:73], v8 offset:17408
    ds_read_b64_tr_b16 v[74:75], v8 offset:17664
    buffer_load_dwordx4 v4, s[24:27], s66 offen lds
    s_waitcnt lgkmcnt(2)
    v_mfma_f32_32x32x16_bf16 v[96:111], v[68:71], a[64:67], v[96:111]
    ds_read_b64_tr_b16 v[64:65], v8 offset:18432
    ds_read_b64_tr_b16 v[66:67], v8 offset:18688
    s_waitcnt lgkmcnt(2)
    v_mfma_f32_32x32x16_bf16 v[96:111], v[72:75], a[68:71], v[96:111]
    ds_read_b64_tr_b16 v[68:69], v8 offset:19456
    ds_read_b64_tr_b16 v[70:71], v8 offset:19712
    s_waitcnt lgkmcnt(2)
    v_mfma_f32_32x32x16_bf16 v[96:111], v[64:67], a[72:75], v[96:111]
    ds_read_b64_tr_b16 v[72:73], v8 offset:20480
    ds_read_b64_tr_b16 v[74:75], v8 offset:20736
    s_waitcnt lgkmcnt(2)
    v_mfma_f32_32x32x16_bf16 v[96:111], v[68:71], a[76:79], v[96:111]
    ds_read_b64_tr_b16 v[64:65], v8 offset:21504
    ds_read_b64_tr_b16 v[66:67], v8 offset:21760
    s_waitcnt lgkmcnt(2)
    v_mfma_f32_32x32x16_bf16 v[96:111], v[72:75], a[80:83], v[96:111]
    ds_read_b64_tr_b16 v[68:69], v8 offset:22528
    ds_read_b64_tr_b16 v[70:71], v8 offset:22784
    buffer_load_dwordx4 v24, s[24:27], s66 offen offset:1024 lds
    s_waitcnt lgkmcnt(2)
    v_mfma_f32_32x32x16_bf16 v[96:111], v[64:67], a[84:87], v[96:111]
    ds_read_b64_tr_b16 v[72:73], v8 offset:23552
    ds_read_b64_tr_b16 v[74:75], v8 offset:23808
    s_waitcnt lgkmcnt(2)
    v_mfma_f32_32x32x16_bf16 v[96:111], v[68:71], a[88:91], v[96:111]
    ds_read_b64_tr_b16 v[64:65], v8 offset:24576
    ds_read_b64_tr_b16 v[66:67], v8 offset:24832
    s_waitcnt lgkmcnt(2)
    v_mfma_f32_32x32x16_bf16 v[96:111], v[72:75], a[92:95], v[96:111]
    ds_read_b64_tr_b16 v[68:69], v8 offset:25600
    ds_read_b64_tr_b16 v[70:71], v8 offset:25856
    s_waitcnt lgkmcnt(2)
    v_mfma_f32_32x32x16_bf16 v[96:111], v[64:67], a[96:99], v[96:111]
    ds_read_b64_tr_b16 v[72:73], v8 offset:26624
    ds_read_b64_tr_b16 v[74:75], v8 offset:26880
    s_waitcnt lgkmcnt(2)
    v_mfma_f32_32x32x16_bf16 v[96:111], v[68:71], a[100:103], v[96:111]
    ds_read_b64_tr_b16 v[64:65], v8 offset:27648
    ds_read_b64_tr_b16 v[66:67], v8 offset:27904
    buffer_load_dwordx4 v25, s[24:27], s66 offen offset:2048 lds
    s_add_u32 s65, s65, s84
    s_add_u32 s66, s66, s85
    s_mov_b32 m0, s65
    s_waitcnt lgkmcnt(2)
    v_mfma_f32_32x32x16_bf16 v[96:111], v[72:75], a[104:107], v[96:111]
    ds_read_b64_tr_b16 v[68:69], v8 offset:28672
    ds_read_b64_tr_b16 v[70:71], v8 offset:28928
    s_waitcnt lgkmcnt(2)
    v_mfma_f32_32x32x16_bf16 v[96:111], v[64:67], a[108:111], v[96:111]
    ds_read_b64_tr_b16 v[72:73], v8 offset:29696
    ds_read_b64_tr_b16 v[74:75], v8 offset:29952
    s_waitcnt lgkmcnt(2)
    v_mfma_f32_32x32x16_bf16 v[96:111], v[68:71], a[112:115], v[96:111]
    ds_read_b64_tr_b16 v[64:65], v8 offset:30720
    ds_read_b64_tr_b16 v[66:67], v8 offset:30976
    s_waitcnt lgkmcnt(2)
    v_mfma_f32_32x32x16_bf16 v[96:111], v[72:75], a[116:119], v[96:111]
    ds_read_b64_tr_b16 v[68:69], v8 offset:31744
    ds_read_b64_tr_b16 v[70:71], v8 offset:32000
    s_waitcnt lgkmcnt(2)
    v_mfma_f32_32x32x16_bf16 v[96:111], v[64:67], a[120:123], v[96:111]
    s_waitcnt lgkmcnt(0)
    v_mfma_f32_32x32x16_bf16 v[96:111], v[68:71], a[124:127], v[96:111]
    v_mov_b32 v12, 0x3eb8aa3b
    s_nop 10
    v_mul_f32 v96, v96, v12
    v_mul_f32 v97, v97, v12
    v_mul_f32 v98, v98, v12
    v_mul_f32 v99, v99, v12
    v_mul_f32 v100, v100, v12
    v_mul_f32 v101, v101, v12
    v_mul_f32 v102, v102, v12
    v_mul_f32 v103, v103, v12
    v_mul_f32 v104, v104, v12
    v_mul_f32 v105, v105, v12
    v_mul_f32 v106, v106, v12
    v_mul_f32 v107, v107, v12
    v_mul_f32 v108, v108, v12
    v_mul_f32 v109, v109, v12
    v_mul_f32 v110, v110, v12
    v_mul_f32 v111, v111, v12
    v_cvt_pk_bf16_f32 v176, v96, v97
    v_cvt_pk_bf16_f32 v177, v98, v99
    v_cvt_pk_bf16_f32 v178, v100, v101
    v_cvt_pk_bf16_f32 v179, v102, v103
    v_cvt_pk_bf16_f32 v180, v104, v105
    v_cvt_pk_bf16_f32 v181, v106, v107
    v_cvt_pk_bf16_f32 v182, v108, v109
    v_cvt_pk_bf16_f32 v183, v110, v111
    s_waitcnt vmcnt(6)
    s_lshl_b32 s57, s45, 13
    s_add_u32 s57, s57, 20447232
    s_lshl_b32 s58, s47, 7
    s_add_u32 s58, s58, s57
    v_mov_b32 v12, s48
    v_mov_b32 v13, 0
    s_mov_b64 exec, 1
    buffer_store_dword v12, v13, s[40:43], s58 offen sc1
    s_mov_b64 exec, -1
    s_lshl_b32 s60, s44, 9
    s_add_u32 s60, s60, 19963904
    s_lshl_b32 s58, s45, 2
    s_add_u32 s58, s58, s46
    s_lshl_b32 s58, s58, 3
    s_add_u32 s58, s58, s60
    v_mov_b32 v12, s48
    v_mov_b32 v13, 0
    s_mov_b64 exec, 1
    s_cmp_eq_u32 s49, 1
    s_cbranch_scc0 L_fs_24
    buffer_store_dword v12, v13, s[40:43], s58 offen
    s_branch L_fe_25
L_fs_24:
    buffer_store_dword v12, v13, s[40:43], s58 offen sc1
L_fe_25:
    s_mov_b64 exec, -1
    buffer_load_dwordx4 v4, s[24:27], s66 offen lds
    buffer_load_dwordx4 v24, s[24:27], s66 offen offset:1024 lds
    buffer_load_dwordx4 v25, s[24:27], s66 offen offset:2048 lds
    s_add_u32 s65, s65, s84
    s_add_u32 s66, s66, s85
    s_mov_b32 m0, s65
    s_nop 0
    buffer_load_dwordx4 v4, s[24:27], s66 offen lds
    buffer_load_dwordx4 v24, s[24:27], s66 offen offset:1024 lds
    buffer_load_dwordx4 v25, s[24:27], s66 offen offset:2048 lds
    s_mul_i32 s56, s64, 8
    s_mul_i32 s57, s82, 7
    s_add_u32 s56, s56, s57
    s_mul_i32 s84, s83, 2048
    s_mul_i32 s85, s83, 16384
    s_mul_i32 s57, s96, 4
    s_mul_i32 s57, s57, s83
    s_add_u32 s56, s56, s57
    s_mul_i32 s95, s96, 8
    s_mul_i32 s95, s95, s83
    s_mul_i32 s65, s56, 2048
    s_add_u32 s65, s65, 98304
    s_mul_i32 s66, s56, 16384
    s_add_u32 s66, s66, s87
    s_mov_b32 m0, s65
    s_nop 0
    buffer_load_dwordx4 v5, s[16:19], s66 offen lds
    buffer_load_dwordx4 v20, s[16:19], s66 offen offset:1024 lds
    s_add_u32 s65, s65, s84
    s_add_u32 s66, s66, s85
    s_mov_b32 m0, s65
    s_nop 0
    buffer_load_dwordx4 v5, s[16:19], s66 offen lds
    buffer_load_dwordx4 v20, s[16:19], s66 offen offset:1024 lds
    s_add_u32 s65, s65, s84
    s_add_u32 s66, s66, s85
    s_mov_b32 m0, s65
    s_nop 0
    buffer_load_dwordx4 v5, s[16:19], s66 offen lds
    buffer_load_dwordx4 v20, s[16:19], s66 offen offset:1024 lds
    s_add_u32 s65, s65, s84
    s_add_u32 s66, s66, s85
    s_mov_b32 m0, s65
    s_cmp_eq_u32 s46, 0
    s_cbranch_scc0 L_s2e_26
    s_lshl_b32 s59, s44, 2
    s_sub_u32 s59, s59, 8
    v_and_b32 v15, 15, v1
    v_add_u32 v12, s59, v15
    v_mov_b32 v14, s47
    v_ashrrev_i32 v13, 31, v12
    v_bfi_b32 v12, v13, v14, v12
    v_lshlrev_b32 v12, 7, v12
    v_lshrrev_b32 v13, 4, v1
    s_lshr_b32 s59, s45, 1
    v_lshl_add_u32 v13, v13, 3, s59
    v_lshl_add_u32 v12, v13, 13, v12
    s_mov_b32 s57, 20447232
    v_lshlrev_b32 v14, 3, v1
    s_mov_b32 s67, 0
L_s2p_27:
    buffer_load_dword v15, v14, s[40:43], s60 offen sc1
    s_mov_b32 exec_lo, 0x0fff0fff
    s_mov_b32 exec_hi, 0
    buffer_load_dword v13, v12, s[40:43], s57 offen sc1
    s_waitcnt vmcnt(0)
    v_cmp_eq_u32 s[62:63], s48, v13
    s_mov_b64 exec, -1
    v_cmp_eq_u32 vcc, s48, v15
    s_add_u32 s67, s67, 1
    s_cmp_gt_u32 s67, 400000
    s_cbranch_scc1 L_s2d_28
    s_cmp_eq_u64 s[62:63], 0x0fff0fff
    s_cbranch_scc0 L_s2p_27
    s_cmp_eq_u64 vcc, -1
    s_cbranch_scc0 L_s2p_27
L_s2d_28:
    s_cmp_gt_u32 s67, 400000
    s_cselect_b32 s56, 1, 0
    s_or_b32 s69, s69, s56
L_s2e_26:
    s_barrier
    s_mul_i32 s56, s46, 3
    s_lshl_b32 s57, s44, 2
    s_add_u32 s57, s57, s56
    s_add_u32 s57, s57, 0
    s_sub_i32 s57, s57, 8
    s_max_i32 s57, s57, 0
    s_lshl_b32 s57, s57, 15
    s_lshl_b32 s58, s45, 11
    s_add_u32 s57, s57, s58
    s_add_u32 s56, s56, 0
    s_lshl_b32 s56, s56, 12
    s_add_u32 s56, s56, 49152
    s_add_u32 m0, s56, 0
    s_add_u32 s58, s57, 4194304
    buffer_load_dwordx4 v2, s[40:43], s58 offen sc1 lds
    s_add_u32 m0, s56, 1024
    s_add_u32 s58, s57, 4195328
    buffer_load_dwordx4 v2, s[40:43], s58 offen sc1 lds
    s_add_u32 m0, s56, 2048
    s_add_u32 s58, s57, 6291456
    buffer_load_dwordx4 v2, s[40:43], s58 offen sc1 lds
    s_add_u32 m0, s56, 3072
    s_add_u32 s58, s57, 6292480
    buffer_load_dwordx4 v2, s[40:43], s58 offen sc1 lds
    s_mul_i32 s56, s46, 3
    s_lshl_b32 s57, s44, 2
    s_add_u32 s57, s57, s56
    s_add_u32 s57, s57, 1
    s_sub_i32 s57, s57, 8
    s_max_i32 s57, s57, 0
    s_lshl_b32 s57, s57, 15
    s_lshl_b32 s58, s45, 11
    s_add_u32 s57, s57, s58
    s_add_u32 s56, s56, 1
    s_lshl_b32 s56, s56, 12
    s_add_u32 s56, s56, 49152
    s_add_u32 m0, s56, 0
    s_add_u32 s58, s57, 4194304
    buffer_load_dwordx4 v2, s[40:43], s58 offen sc1 lds
    s_add_u32 m0, s56, 1024
    s_add_u32 s58, s57, 4195328
    buffer_load_dwordx4 v2, s[40:43], s58 offen sc1 lds
    s_add_u32 m0, s56, 2048
    s_add_u32 s58, s57, 6291456
    buffer_load_dwordx4 v2, s[40:43], s58 offen sc1 lds
    s_add_u32 m0, s56, 3072
    s_add_u32 s58, s57, 6292480
    buffer_load_dwordx4 v2, s[40:43], s58 offen sc1 lds
    s_mul_i32 s56, s46, 3
    s_lshl_b32 s57, s44, 2
    s_add_u32 s57, s57, s56
    s_add_u32 s57, s57, 2
    s_sub_i32 s57, s57, 8
    s_max_i32 s57, s57, 0
    s_lshl_b32 s57, s57, 15
    s_lshl_b32 s58, s45, 11
    s_add_u32 s57, s57, s58
    s_add_u32 s56, s56, 2
    s_lshl_b32 s56, s56, 12
    s_add_u32 s56, s56, 49152
    s_add_u32 m0, s56, 0
    s_add_u32 s58, s57, 4194304
    buffer_load_dwordx4 v2, s[40:43], s58 offen sc1 lds
    s_add_u32 m0, s56, 1024
    s_add_u32 s58, s57, 4195328
    buffer_load_dwordx4 v2, s[40:43], s58 offen sc1 lds
    s_add_u32 m0, s56, 2048
    s_add_u32 s58, s57, 6291456
    buffer_load_dwordx4 v2, s[40:43], s58 offen sc1 lds
    s_add_u32 m0, s56, 3072
    s_add_u32 s58, s57, 6292480
    buffer_load_dwordx4 v2, s[40:43], s58 offen sc1 lds
    s_waitcnt vmcnt(0)
    s_barrier
    s_lshl_b32 s56, s46, 12
    s_add_u32 s56, s56, 49152
    v_add_u32 v14, s56, v2
    ds_read_b128 a[64:67], v14 offset:32768
    ds_read_b128 a[68:71], v14 offset:33792
    ds_read_b128 a[56:59], v14 offset:28672
    ds_read_b128 a[60:63], v14 offset:29696
    ds_read_b128 a[48:51], v14 offset:24576
    ds_read_b128 a[52:55], v14 offset:25600
    ds_read_b128 a[40:43], v14 offset:20480
    ds_read_b128 a[44:47], v14 offset:21504
    ds_read_b128 a[32:35], v14 offset:16384
    ds_read_b128 a[36:39], v14 offset:17408
    ds_read_b128 a[24:27], v14 offset:12288
    ds_read_b128 a[28:31], v14 offset:13312
    ds_read_b128 a[16:19], v14 offset:8192
    ds_read_b128 a[20:23], v14 offset:9216
    ds_read_b128 a[8:11], v14 offset:4096
    ds_read_b128 a[12:15], v14 offset:5120
    ds_read_b128 a[0:3], v14 offset:0
    ds_read_b128 a[4:7], v14 offset:1024
    v_mov_b32 v12, 0xf149f2ca
    v_mov_b32 v184, v12
    v_mov_b32 v185, v12
    v_mov_b32 v186, v12
    v_mov_b32 v187, v12
    v_mov_b64 v[160:161], 0
    v_mov_b64 v[162:163], 0
    v_mov_b64 v[164:165], 0
    v_mov_b64 v[166:167], 0
    v_mov_b64 v[168:169], 0
    v_mov_b64 v[170:171], 0
    v_mov_b64 v[172:173], 0
    v_mov_b64 v[174:175], 0
    v_mov_b32 v13, 0xf149f2ca
    s_mov_b32 s64, s46
    s_cmp_eq_u32 s46, 3
    s_cbranch_scc0 L_wdt_29
    s_mul_i32 s56, s2, 2816
    s_add_u32 s56, s56, 704512
    v_lshlrev_b32 v31, 7, v1
    s_mov_b32 exec_lo, 0x3fffff
    s_mov_b32 exec_hi, 0x0
    buffer_load_dword v30, v31, s[20:23], s56 offen
    s_mov_b64 exec, -1
    s_mul_i32 s56, s2, 2816
    s_add_u32 s56, s56, 704512
    v_lshlrev_b32 v29, 7, v1
    s_mov_b32 exec_lo, 0x3fffff
    s_mov_b32 exec_hi, 0x0
    buffer_load_dword v28, v29, s[24:27], s56 offen
    s_mov_b64 exec, -1
    s_mul_i32 s56, s2, 5504
    v_lshlrev_b32 v31, 7, v1
    s_mov_b32 exec_lo, 0xffffffff
    s_mov_b32 exec_hi, 0x7ff
    buffer_load_dword v30, v31, s[28:31], s56 offen
    s_mov_b64 exec, -1
L_wdt_29:
    s_waitcnt lgkmcnt(15)
    v_mfma_f32_32x32x16_bf16 v[32:47], a[64:67], v[176:179], v[216:231]
    v_mfma_f32_32x32x16_bf16 v[64:79], a[68:71], v[180:183], v[216:231]
    s_waitcnt lgkmcnt(14)
    s_cmp_eq_u32 s47, 0
    s_cbranch_scc1 L_rare_30
L_back_31:
    v_mfma_f32_32x32x16_bf16 v[48:63], a[56:59], v[176:179], v[160:175]
    s_nop 6
    v_max3_f32 v184, v32, v33, v184
    v_max3_f32 v185, v34, v35, v185
    v_max3_f32 v184, v36, v37, v184
    v_max3_f32 v185, v38, v39, v185
    v_max3_f32 v184, v40, v41, v184
    v_max3_f32 v185, v42, v43, v185
    v_max3_f32 v184, v44, v45, v184
    v_max3_f32 v185, v46, v47, v185
    v_mfma_f32_32x32x16_bf16 v[80:95], a[60:63], v[180:183], v[160:175]
    v_max3_f32 v186, v64, v65, v186
    v_max3_f32 v187, v66, v67, v187
    v_max3_f32 v186, v68, v69, v186
    v_max3_f32 v187, v70, v71, v187
    v_max3_f32 v186, v72, v73, v186
    v_max3_f32 v187, v74, v75, v187
    v_max3_f32 v186, v76, v77, v186
    v_max3_f32 v187, v78, v79, v187
    s_mov_b32 m0, s65
    s_waitcnt lgkmcnt(0)
    s_mov_b64 exec, s[70:71]
    ds_read_b128 v[240:243], v14 offset:34816
    ds_read_b128 v[244:247], v14 offset:35840
    ds_read_b128 v[248:251], v14 offset:35072
    ds_read_b128 v[252:255], v14 offset:36096
    s_mov_b64 exec, -1
    s_cmp_eq_u32 s47, 1
    s_cbranch_scc1 L_rare_32
L_back_33:
    v_mfma_f32_32x32x16_bf16 v[32:47], a[48:51], v[176:179], v[160:175]
    v_max3_f32 v184, v48, v49, v184
    v_max3_f32 v185, v50, v51, v185
    v_max3_f32 v184, v52, v53, v184
    v_max3_f32 v185, v54, v55, v185
    v_max3_f32 v184, v56, v57, v184
    v_max3_f32 v185, v58, v59, v185
    v_max3_f32 v184, v60, v61, v184
    v_max3_f32 v185, v62, v63, v185
    v_mfma_f32_32x32x16_bf16 v[64:79], a[52:55], v[180:183], v[160:175]
    v_max3_f32 v186, v80, v81, v186
    v_max3_f32 v187, v82, v83, v187
    v_max3_f32 v186, v84, v85, v186
    v_max3_f32 v187, v86, v87, v187
    v_max3_f32 v186, v88, v89, v186
    v_max3_f32 v187, v90, v91, v187
    v_max3_f32 v186, v92, v93, v186
    v_max3_f32 v187, v94, v95, v187
    buffer_load_dwordx4 v5, s[16:19], s66 offen lds
    s_mov_b64 exec, s[70:71]
    ds_read_b128 a[240:243], v14 offset:30720
    ds_read_b128 a[244:247], v14 offset:31744
    ds_read_b128 a[248:251], v14 offset:30976
    ds_read_b128 a[252:255], v14 offset:32000
    s_mov_b64 exec, -1
    s_mov_b64 exec, s[70:71]
    ds_read_b128 a[224:227], v14 offset:26624
    ds_read_b128 a[228:231], v14 offset:27648
    ds_read_b128 a[232:235], v14 offset:26880
    ds_read_b128 a[236:239], v14 offset:27904
    s_mov_b64 exec, -1
    s_cmp_eq_u32 s47, 2
    s_cbranch_scc1 L_rare_34
L_back_35:
    v_mfma_f32_32x32x16_bf16 v[48:63], a[40:43], v[176:179], v[160:175]
    v_max3_f32 v184, v32, v33, v184
    v_max3_f32 v185, v34, v35, v185
    v_max3_f32 v184, v36, v37, v184
    v_max3_f32 v185, v38, v39, v185
    v_max3_f32 v184, v40, v41, v184
    v_max3_f32 v185, v42, v43, v185
    v_max3_f32 v184, v44, v45, v184
    v_max3_f32 v185, v46, v47, v185
    v_mfma_f32_32x32x16_bf16 v[80:95], a[44:47], v[180:183], v[160:175]
    v_max3_f32 v186, v64, v65, v186
    v_max3_f32 v187, v66, v67, v187
    v_max3_f32 v186, v68, v69, v186
    v_max3_f32 v187, v70, v71, v187
    v_max3_f32 v186, v72, v73, v186
    v_max3_f32 v187, v74, v75, v187
    v_max3_f32 v186, v76, v77, v186
    v_max3_f32 v187, v78, v79, v187
    s_mov_b64 exec, s[70:71]
    ds_read_b128 a[208:211], v14 offset:22528
    ds_read_b128 a[212:215], v14 offset:23552
    ds_read_b128 a[216:219], v14 offset:22784
    ds_read_b128 a[220:223], v14 offset:23808
    s_mov_b64 exec, -1
    s_cmp_eq_u32 s47, 3
    s_cbranch_scc1 L_rare_36
L_back_37:
    v_mfma_f32_32x32x16_bf16 v[32:47], a[32:35], v[176:179], v[160:175]
    v_max3_f32 v184, v48, v49, v184
    v_max3_f32 v185, v50, v51, v185
    v_max3_f32 v184, v52, v53, v184
    v_max3_f32 v185, v54, v55, v185
    v_max3_f32 v184, v56, v57, v184
    v_max3_f32 v185, v58, v59, v185
    v_max3_f32 v184, v60, v61, v184
    v_max3_f32 v185, v62, v63, v185
    v_mfma_f32_32x32x16_bf16 v[64:79], a[36:39], v[180:183], v[160:175]
    v_max3_f32 v186, v80, v81, v186
    v_max3_f32 v187, v82, v83, v187
    v_max3_f32 v186, v84, v85, v186
    v_max3_f32 v187, v86, v87, v187
    v_max3_f32 v186, v88, v89, v186
    v_max3_f32 v187, v90, v91, v187
    v_max3_f32 v186, v92, v93, v186
    v_max3_f32 v187, v94, v95, v187
    buffer_load_dwordx4 v20, s[16:19], s66 offen offset:1024 lds
    s_sub_u32 s56, s83, s95
    s_mul_i32 s57, s56, 2048
    s_add_u32 s65, s65, s57
    s_mul_i32 s57, s56, 16384
    s_add_u32 s66, s66, s57
    s_mov_b32 m0, s65
    s_mov_b64 exec, s[70:71]
    ds_read_b128 a[192:195], v14 offset:18432
    ds_read_b128 a[196:199], v14 offset:19456
    ds_read_b128 a[200:203], v14 offset:18688
    ds_read_b128 a[204:207], v14 offset:19712
    s_mov_b64 exec, -1
    s_mov_b64 exec, s[70:71]
    ds_read_b128 a[176:179], v14 offset:14336
    ds_read_b128 a[180:183], v14 offset:15360
    ds_read_b128 a[184:187], v14 offset:14592
    ds_read_b128 a[188:191], v14 offset:15616
    s_mov_b64 exec, -1
    s_cmp_eq_u32 s47, 4
    s_cbranch_scc1 L_rare_38
L_back_39:
    v_mfma_f32_32x32x16_bf16 v[48:63], a[24:27], v[176:179], v[160:175]
    v_max3_f32 v184, v32, v33, v184
    v_max3_f32 v185, v34, v35, v185
    v_max3_f32 v184, v36, v37, v184
    v_max3_f32 v185, v38, v39, v185
    v_max3_f32 v184, v40, v41, v184
    v_max3_f32 v185, v42, v43, v185
    v_max3_f32 v184, v44, v45, v184
    v_max3_f32 v185, v46, v47, v185
    v_mfma_f32_32x32x16_bf16 v[80:95], a[28:31], v[180:183], v[160:175]
    v_max3_f32 v186, v64, v65, v186
    v_max3_f32 v187, v66, v67, v187
    v_max3_f32 v186, v68, v69, v186
    v_max3_f32 v187, v70, v71, v187
    v_max3_f32 v186, v72, v73, v186
    v_max3_f32 v187, v74, v75, v187
    v_max3_f32 v186, v76, v77, v186
    v_max3_f32 v187, v78, v79, v187
    s_mov_b64 exec, s[70:71]
    ds_read_b128 a[160:163], v14 offset:10240
    ds_read_b128 a[164:167], v14 offset:11264
    ds_read_b128 a[168:171], v14 offset:10496
    ds_read_b128 a[172:175], v14 offset:11520
    s_mov_b64 exec, -1
    s_cmp_eq_u32 s47, 5
    s_cbranch_scc1 L_rare_40
L_back_41:
    v_mfma_f32_32x32x16_bf16 v[32:47], a[16:19], v[176:179], v[160:175]
    v_max3_f32 v184, v48, v49, v184
    v_max3_f32 v185, v50, v51, v185
    v_max3_f32 v184, v52, v53, v184
    v_max3_f32 v185, v54, v55, v185
    v_max3_f32 v184, v56, v57, v184
    v_max3_f32 v185, v58, v59, v185
    v_max3_f32 v184, v60, v61, v184
    v_max3_f32 v185, v62, v63, v185
    v_mfma_f32_32x32x16_bf16 v[64:79], a[20:23], v[180:183], v[160:175]
    v_max3_f32 v186, v80, v81, v186
    v_max3_f32 v187, v82, v83, v187
    v_max3_f32 v186, v84, v85, v186
    v_max3_f32 v187, v86, v87, v187
    v_max3_f32 v186, v88, v89, v186
    v_max3_f32 v187, v90, v91, v187
    v_max3_f32 v186, v92, v93, v186
    v_max3_f32 v187, v94, v95, v187
    buffer_load_dwordx4 v5, s[16:19], s66 offen lds
    s_mov_b64 exec, s[70:71]
    ds_read_b128 a[144:147], v14 offset:6144
    ds_read_b128 a[148:151], v14 offset:7168
    ds_read_b128 a[152:155], v14 offset:6400
    ds_read_b128 a[156:159], v14 offset:7424
    s_mov_b64 exec, -1
    s_mov_b64 exec, s[70:71]
    ds_read_b128 a[128:131], v14 offset:2048
    ds_read_b128 a[132:135], v14 offset:3072
    ds_read_b128 a[136:139], v14 offset:2304
    ds_read_b128 a[140:143], v14 offset:3328
    s_mov_b64 exec, -1
    s_cmp_eq_u32 s47, 6
    s_cbranch_scc1 L_rare_42
L_back_43:
    v_mfma_f32_32x32x16_bf16 v[48:63], a[8:11], v[176:179], v[160:175]
    v_max3_f32 v184, v32, v33, v184
    v_max3_f32 v185, v34, v35, v185
    v_max3_f32 v184, v36, v37, v184
    v_max3_f32 v185, v38, v39, v185
    v_max3_f32 v184, v40, v41, v184
    v_max3_f32 v185, v42, v43, v185
    v_max3_f32 v184, v44, v45, v184
    v_max3_f32 v185, v46, v47, v185
    v_mfma_f32_32x32x16_bf16 v[80:95], a[12:15], v[180:183], v[160:175]
    v_max3_f32 v186, v64, v65, v186
    v_max3_f32 v187, v66, v67, v187
    v_max3_f32 v186, v68, v69, v186
    v_max3_f32 v187, v70, v71, v187
    v_max3_f32 v186, v72, v73, v186
    v_max3_f32 v187, v74, v75, v187
    v_max3_f32 v186, v76, v77, v186
    v_max3_f32 v187, v78, v79, v187
    s_cmp_eq_u32 s47, 7
    s_cbranch_scc1 L_rare_44
L_back_45:
    v_mfma_f32_32x32x16_bf16 v[32:47], a[0:3], v[176:179], v[200:215]
    v_max3_f32 v184, v48, v49, v184
    v_max3_f32 v185, v50, v51, v185
    v_max3_f32 v184, v52, v53, v184
    v_max3_f32 v185, v54, v55, v185
    v_max3_f32 v184, v56, v57, v184
    v_max3_f32 v185, v58, v59, v185
    v_max3_f32 v184, v60, v61, v184
    v_max3_f32 v185, v62, v63, v185
    v_mfma_f32_32x32x16_bf16 v[64:79], a[4:7], v[180:183], v[200:215]
    v_max3_f32 v186, v80, v81, v186
    v_max3_f32 v187, v82, v83, v187
    v_max3_f32 v186, v84, v85, v186
    v_max3_f32 v187, v86, v87, v187
    v_max3_f32 v186, v88, v89, v186
    v_max3_f32 v187, v90, v91, v187
    v_max3_f32 v186, v92, v93, v186
    v_max3_f32 v187, v94, v95, v187
    buffer_load_dwordx4 v20, s[16:19], s66 offen offset:1024 lds
    s_add_u32 s65, s65, s84
    s_add_u32 s66, s66, s85
    s_mov_b32 m0, s65
    v_max3_f32 v184, v32, v33, v184
    v_max3_f32 v185, v34, v35, v185
    v_max3_f32 v184, v36, v37, v184
    v_max3_f32 v185, v38, v39, v185
    v_max3_f32 v184, v40, v41, v184
    v_max3_f32 v185, v42, v43, v185
    v_max3_f32 v184, v44, v45, v184
    v_max3_f32 v185, v46, v47, v185
    v_max3_f32 v186, v64, v65, v186
    v_max3_f32 v187, v66, v67, v187
    v_max3_f32 v186, v68, v69, v186
    v_max3_f32 v187, v70, v71, v187
    v_max3_f32 v186, v72, v73, v186
    v_max3_f32 v187, v74, v75, v187
    v_max3_f32 v186, v76, v77, v186
    v_max3_f32 v187, v78, v79, v187
    v_max_f32 v184, v184, v185
    v_mov_b32 v185, v184
    v_max_f32 v186, v186, v187
    v_mov_b32 v187, v186
    v_permlane32_swap_b32 v184, v185
    s_nop 0
    v_permlane32_swap_b32 v186, v187
    v_max_f32 v184, v184, v185
    v_sub_f32 v96, 0, v184
    v_max_f32 v186, v186, v187
    v_sub_f32 v112, 0, v186
    v_mov_b32 v97, v96
    v_mov_b32 v113, v112
    v_mov_b64 v[98:99], v[96:97]
    v_mov_b64 v[100:101], v[96:97]
    v_mov_b64 v[102:103], v[96:97]
    v_mov_b64 v[104:105], v[96:97]
    v_mov_b64 v[106:107], v[96:97]
    v_mov_b64 v[108:109], v[96:97]
    v_mov_b64 v[110:111], v[96:97]
    v_mov_b64 v[114:115], v[112:113]
    v_mov_b64 v[116:117], v[112:113]
    v_mov_b64 v[118:119], v[112:113]
    v_mov_b64 v[120:121], v[112:113]
    v_mov_b64 v[122:123], v[112:113]
    v_mov_b64 v[124:125], v[112:113]
    v_mov_b64 v[126:127], v[112:113]
    s_waitcnt lgkmcnt(0)
    s_barrier
    v_mfma_f32_32x32x16_bf16 v[32:47], a[64:67], v[176:179], v[96:111]
    v_mfma_f32_32x32x16_bf16 v[64:79], a[68:71], v[180:183], v[112:127]
    s_cmp_eq_u32 s47, 0
    s_cbranch_scc1 L_rare_46
L_back_47:
    s_nop 8
    v_exp_f32 v32, v32
    v_exp_f32 v33, v33
    v_exp_f32 v34, v34
    v_exp_f32 v35, v35
    v_mfma_f32_32x32x16_bf16 v[48:63], a[56:59], v[176:179], v[96:111]
    v_exp_f32 v36, v36
    v_exp_f32 v37, v37
    v_exp_f32 v38, v38
    v_exp_f32 v39, v39
    v_exp_f32 v40, v40
    v_exp_f32 v41, v41
    v_exp_f32 v42, v42
    v_exp_f32 v43, v43
    v_exp_f32 v44, v44
    v_exp_f32 v45, v45
    v_exp_f32 v46, v46
    v_exp_f32 v47, v47
    v_cvt_pk_bf16_f32 v160, v32, v33
    v_cvt_pk_bf16_f32 v161, v34, v35
    v_cvt_pk_bf16_f32 v162, v36, v37
    v_cvt_pk_bf16_f32 v163, v38, v39
    v_cvt_pk_bf16_f32 v164, v40, v41
    v_cvt_pk_bf16_f32 v165, v42, v43
    v_cvt_pk_bf16_f32 v166, v44, v45
    v_cvt_pk_bf16_f32 v167, v46, v47
    v_and_b32 v160, v232, v160
    v_and_b32 v161, v233, v161
    v_and_b32 v162, v234, v162
    v_and_b32 v163, v235, v163
    v_and_b32 v164, v236, v164
    v_and_b32 v165, v237, v165
    v_and_b32 v166, v238, v166
    v_and_b32 v167, v239, v167
    buffer_load_dwordx4 v5, s[16:19], s66 offen lds
    v_exp_f32 v64, v64
    v_exp_f32 v65, v65
    v_exp_f32 v66, v66
    v_exp_f32 v67, v67
    v_mfma_f32_32x32x16_bf16 v[128:143], v[240:243], v[160:163], 0
    v_exp_f32 v68, v68
    v_exp_f32 v69, v69
    v_exp_f32 v70, v70
    v_exp_f32 v71, v71
    v_mfma_f32_32x32x16_bf16 v[128:143], v[244:247], v[164:167], v[128:143]
    v_exp_f32 v72, v72
    v_exp_f32 v73, v73
    v_exp_f32 v74, v74
    v_exp_f32 v75, v75
    v_mfma_f32_32x32x16_bf16 v[80:95], a[60:63], v[180:183], v[112:127]
    v_exp_f32 v76, v76
    v_exp_f32 v77, v77
    v_exp_f32 v78, v78
    v_exp_f32 v79, v79
    v_cvt_pk_bf16_f32 v168, v64, v65
    v_cvt_pk_bf16_f32 v169, v66, v67
    v_cvt_pk_bf16_f32 v170, v68, v69
    v_cvt_pk_bf16_f32 v171, v70, v71
    v_cvt_pk_bf16_f32 v172, v72, v73
    v_cvt_pk_bf16_f32 v173, v74, v75
    v_cvt_pk_bf16_f32 v174, v76, v77
    v_cvt_pk_bf16_f32 v175, v78, v79
    v_and_b32 v168, v232, v168
    v_and_b32 v169, v233, v169
    v_and_b32 v170, v234, v170
    v_and_b32 v171, v235, v171
    v_and_b32 v172, v236, v172
    v_and_b32 v173, v237, v173
    v_and_b32 v174, v238, v174
    v_and_b32 v175, v239, v175
    buffer_load_dwordx4 v20, s[16:19], s66 offen offset:1024 lds
    s_add_u32 s65, s65, s84
    s_add_u32 s66, s66, s85
    s_mov_b32 m0, s65
    s_nop 0
    buffer_load_dwordx4 v5, s[16:19], s66 offen lds
    s_cmp_eq_u32 s47, 1
    s_cbranch_scc1 L_rare_48
L_back_49:
    v_exp_f32 v48, v48
    v_exp_f32 v49, v49
    v_exp_f32 v50, v50
    v_exp_f32 v51, v51
    v_mfma_f32_32x32x16_bf16 v[144:159], v[248:251], v[168:171], 0
    v_exp_f32 v52, v52
    v_exp_f32 v53, v53
    v_exp_f32 v54, v54
    v_exp_f32 v55, v55
    v_mfma_f32_32x32x16_bf16 v[144:159], v[252:255], v[172:175], v[144:159]
    v_exp_f32 v56, v56
    v_exp_f32 v57, v57
    v_exp_f32 v58, v58
    v_exp_f32 v59, v59
    v_mfma_f32_32x32x16_bf16 v[32:47], a[48:51], v[176:179], v[96:111]
    v_exp_f32 v60, v60
    v_exp_f32 v61, v61
    v_exp_f32 v62, v62
    v_exp_f32 v63, v63
    v_cvt_pk_bf16_f32 v160, v48, v49
    v_cvt_pk_bf16_f32 v161, v50, v51
    v_cvt_pk_bf16_f32 v162, v52, v53
    v_cvt_pk_bf16_f32 v163, v54, v55
    v_cvt_pk_bf16_f32 v164, v56, v57
    v_cvt_pk_bf16_f32 v165, v58, v59
    v_cvt_pk_bf16_f32 v166, v60, v61
    v_cvt_pk_bf16_f32 v167, v62, v63
    buffer_load_dwordx4 v20, s[16:19], s66 offen offset:1024 lds
    s_add_u32 s65, s65, s84
    s_add_u32 s66, s66, s85
    s_mov_b32 m0, s65
    v_exp_f32 v80, v80
    v_exp_f32 v81, v81
    v_exp_f32 v82, v82
    v_exp_f32 v83, v83
    v_mfma_f32_32x32x16_bf16 v[128:143], a[240:243], v[160:163], v[128:143]
    v_exp_f32 v84, v84
    v_exp_f32 v85, v85
    v_exp_f32 v86, v86
    v_exp_f32 v87, v87
    v_mfma_f32_32x32x16_bf16 v[128:143], a[244:247], v[164:167], v[128:143]
    v_exp_f32 v88, v88
    v_exp_f32 v89, v89
    v_exp_f32 v90, v90
    v_exp_f32 v91, v91
    v_mfma_f32_32x32x16_bf16 v[64:79], a[52:55], v[180:183], v[112:127]
    v_exp_f32 v92, v92
    v_exp_f32 v93, v93
    v_exp_f32 v94, v94
    v_exp_f32 v95, v95
    v_cvt_pk_bf16_f32 v168, v80, v81
    v_cvt_pk_bf16_f32 v169, v82, v83
    v_cvt_pk_bf16_f32 v170, v84, v85
    v_cvt_pk_bf16_f32 v171, v86, v87
    v_cvt_pk_bf16_f32 v172, v88, v89
    v_cvt_pk_bf16_f32 v173, v90, v91
    v_cvt_pk_bf16_f32 v174, v92, v93
    v_cvt_pk_bf16_f32 v175, v94, v95
    buffer_load_dwordx4 v5, s[16:19], s66 offen lds
    s_cmp_eq_u32 s47, 2
    s_cbranch_scc1 L_rare_50
L_back_51:
    v_exp_f32 v32, v32
    v_exp_f32 v33, v33
    v_exp_f32 v34, v34
    v_exp_f32 v35, v35
    v_mfma_f32_32x32x16_bf16 v[144:159], a[248:251], v[168:171], v[144:159]
    v_exp_f32 v36, v36
    v_exp_f32 v37, v37
    v_exp_f32 v38, v38
    v_exp_f32 v39, v39
    v_mfma_f32_32x32x16_bf16 v[144:159], a[252:255], v[172:175], v[144:159]
    v_exp_f32 v40, v40
    v_exp_f32 v41, v41
    v_exp_f32 v42, v42
    v_exp_f32 v43, v43
    v_mfma_f32_32x32x16_bf16 v[48:63], a[40:43], v[176:179], v[96:111]
    v_exp_f32 v44, v44
    v_exp_f32 v45, v45
    v_exp_f32 v46, v46
    v_exp_f32 v47, v47
    v_cvt_pk_bf16_f32 v160, v32, v33
    v_cvt_pk_bf16_f32 v161, v34, v35
    v_cvt_pk_bf16_f32 v162, v36, v37
    v_cvt_pk_bf16_f32 v163, v38, v39
    v_cvt_pk_bf16_f32 v164, v40, v41
    v_cvt_pk_bf16_f32 v165, v42, v43
    v_cvt_pk_bf16_f32 v166, v44, v45
    v_cvt_pk_bf16_f32 v167, v46, v47
    buffer_load_dwordx4 v20, s[16:19], s66 offen offset:1024 lds
    v_exp_f32 v64, v64
    v_exp_f32 v65, v65
    v_exp_f32 v66, v66
    v_exp_f32 v67, v67
    v_mfma_f32_32x32x16_bf16 v[128:143], a[224:227], v[160:163], v[128:143]
    v_exp_f32 v68, v68
    v_exp_f32 v69, v69
    v_exp_f32 v70, v70
    v_exp_f32 v71, v71
    v_mfma_f32_32x32x16_bf16 v[128:143], a[228:231], v[164:167], v[128:143]
    v_exp_f32 v72, v72
    v_exp_f32 v73, v73
    v_exp_f32 v74, v74
    v_exp_f32 v75, v75
    v_mfma_f32_32x32x16_bf16 v[80:95], a[44:47], v[180:183], v[112:127]
    v_exp_f32 v76, v76
    v_exp_f32 v77, v77
    v_exp_f32 v78, v78
    v_exp_f32 v79, v79
    v_cvt_pk_bf16_f32 v168, v64, v65
    v_cvt_pk_bf16_f32 v169, v66, v67
    v_cvt_pk_bf16_f32 v170, v68, v69
    v_cvt_pk_bf16_f32 v171, v70, v71
    v_cvt_pk_bf16_f32 v172, v72, v73
    v_cvt_pk_bf16_f32 v173, v74, v75
    v_cvt_pk_bf16_f32 v174, v76, v77
    v_cvt_pk_bf16_f32 v175, v78, v79
    buffer_load_dwordx4 v[192:195], v10, s[8:11], s91 offen
    buffer_load_dwordx4 v[196:199], v10, s[8:11], s91 offen offset:32
    s_cmp_eq_u32 s47, 3
    s_cbranch_scc1 L_rare_52
L_back_53:
    v_exp_f32 v48, v48
    v_exp_f32 v49, v49
    v_exp_f32 v50, v50
    v_exp_f32 v51, v51
    v_mfma_f32_32x32x16_bf16 v[144:159], a[232:235], v[168:171], v[144:159]
    v_exp_f32 v52, v52
    v_exp_f32 v53, v53
    v_exp_f32 v54, v54
    v_exp_f32 v55, v55
    v_mfma_f32_32x32x16_bf16 v[144:159], a[236:239], v[172:175], v[144:159]
    v_exp_f32 v56, v56
    v_exp_f32 v57, v57
    v_exp_f32 v58, v58
    v_exp_f32 v59, v59
    v_mfma_f32_32x32x16_bf16 v[32:47], a[32:35], v[176:179], v[96:111]
    v_exp_f32 v60, v60
    v_exp_f32 v61, v61
    v_exp_f32 v62, v62
    v_exp_f32 v63, v63
    v_cvt_pk_bf16_f32 v160, v48, v49
    v_cvt_pk_bf16_f32 v161, v50, v51
    v_cvt_pk_bf16_f32 v162, v52, v53
    v_cvt_pk_bf16_f32 v163, v54, v55
    v_cvt_pk_bf16_f32 v164, v56, v57
    v_cvt_pk_bf16_f32 v165, v58, v59
    v_cvt_pk_bf16_f32 v166, v60, v61
    v_cvt_pk_bf16_f32 v167, v62, v63
    s_mul_i32 s56, s64, 4
    s_mul_i32 s57, s82, 3
    s_add_u32 s56, s56, s57
    s_mul_i32 s84, s83, 3072
    s_mul_i32 s85, s83, 44032
    s_mul_i32 s65, s56, 3072
    s_add_u32 s65, s65, 49152
    s_mul_i32 s66, s56, 44032
    s_add_u32 s66, s66, s88
    s_mov_b32 m0, s65
    s_nop 0
    buffer_load_dwordx4 v4, s[20:23], s66 offen lds
    buffer_load_dwordx4 v24, s[20:23], s66 offen offset:1024 lds
    v_exp_f32 v80, v80
    v_exp_f32 v81, v81
    v_exp_f32 v82, v82
    v_exp_f32 v83, v83
    v_mfma_f32_32x32x16_bf16 v[128:143], a[208:211], v[160:163], v[128:143]
    v_exp_f32 v84, v84
    v_exp_f32 v85, v85
    v_exp_f32 v86, v86
    v_exp_f32 v87, v87
    v_mfma_f32_32x32x16_bf16 v[128:143], a[212:215], v[164:167], v[128:143]
    v_exp_f32 v88, v88
    v_exp_f32 v89, v89
    v_exp_f32 v90, v90
    v_exp_f32 v91, v91
    v_mfma_f32_32x32x16_bf16 v[64:79], a[36:39], v[180:183], v[112:127]
    v_exp_f32 v92, v92
    v_exp_f32 v93, v93
    v_exp_f32 v94, v94
    v_exp_f32 v95, v95
    v_cvt_pk_bf16_f32 v168, v80, v81
    v_cvt_pk_bf16_f32 v169, v82, v83
    v_cvt_pk_bf16_f32 v170, v84, v85
    v_cvt_pk_bf16_f32 v171, v86, v87
    v_cvt_pk_bf16_f32 v172, v88, v89
    v_cvt_pk_bf16_f32 v173, v90, v91
    v_cvt_pk_bf16_f32 v174, v92, v93
    v_cvt_pk_bf16_f32 v175, v94, v95
    buffer_load_dwordx4 v25, s[20:23], s66 offen offset:2048 lds
    s_add_u32 s65, s65, s84
    s_add_u32 s66, s66, s85
    s_mov_b32 m0, s65
    s_cmp_eq_u32 s47, 4
    s_cbranch_scc1 L_rare_54
L_back_55:
    v_exp_f32 v32, v32
    v_exp_f32 v33, v33
    v_exp_f32 v34, v34
    v_exp_f32 v35, v35
    v_mfma_f32_32x32x16_bf16 v[144:159], a[216:219], v[168:171], v[144:159]
    v_exp_f32 v36, v36
    v_exp_f32 v37, v37
    v_exp_f32 v38, v38
    v_exp_f32 v39, v39
    v_mfma_f32_32x32x16_bf16 v[144:159], a[220:223], v[172:175], v[144:159]
    v_exp_f32 v40, v40
    v_exp_f32 v41, v41
    v_exp_f32 v42, v42
    v_exp_f32 v43, v43
    v_mfma_f32_32x32x16_bf16 v[48:63], a[24:27], v[176:179], v[96:111]
    v_exp_f32 v44, v44
    v_exp_f32 v45, v45
    v_exp_f32 v46, v46
    v_exp_f32 v47, v47
    v_cvt_pk_bf16_f32 v160, v32, v33
    v_cvt_pk_bf16_f32 v161, v34, v35
    v_cvt_pk_bf16_f32 v162, v36, v37
    v_cvt_pk_bf16_f32 v163, v38, v39
    v_cvt_pk_bf16_f32 v164, v40, v41
    v_cvt_pk_bf16_f32 v165, v42, v43
    v_cvt_pk_bf16_f32 v166, v44, v45
    v_cvt_pk_bf16_f32 v167, v46, v47
    buffer_load_dwordx4 v4, s[20:23], s66 offen lds
    v_exp_f32 v64, v64
    v_exp_f32 v65, v65
    v_exp_f32 v66, v66
    v_exp_f32 v67, v67
    v_mfma_f32_32x32x16_bf16 v[128:143], a[192:195], v[160:163], v[128:143]
    v_exp_f32 v68, v68
    v_exp_f32 v69, v69
    v_exp_f32 v70, v70
    v_exp_f32 v71, v71
    v_mfma_f32_32x32x16_bf16 v[128:143], a[196:199], v[164:167], v[128:143]
    v_exp_f32 v72, v72
    v_exp_f32 v73, v73
    v_exp_f32 v74, v74
    v_exp_f32 v75, v75
    v_mfma_f32_32x32x16_bf16 v[80:95], a[28:31], v[180:183], v[112:127]
    v_exp_f32 v76, v76
    v_exp_f32 v77, v77
    v_exp_f32 v78, v78
    v_exp_f32 v79, v79
    v_cvt_pk_bf16_f32 v168, v64, v65
    v_cvt_pk_bf16_f32 v169, v66, v67
    v_cvt_pk_bf16_f32 v170, v68, v69
    v_cvt_pk_bf16_f32 v171, v70, v71
    v_cvt_pk_bf16_f32 v172, v72, v73
    v_cvt_pk_bf16_f32 v173, v74, v75
    v_cvt_pk_bf16_f32 v174, v76, v77
    v_cvt_pk_bf16_f32 v175, v78, v79
    buffer_load_dwordx4 v24, s[20:23], s66 offen offset:1024 lds
    s_cmp_eq_u32 s47, 5
    s_cbranch_scc1 L_rare_56
L_back_57:
    v_exp_f32 v48, v48
    v_exp_f32 v49, v49
    v_exp_f32 v50, v50
    v_exp_f32 v51, v51
    v_mfma_f32_32x32x16_bf16 v[144:159], a[200:203], v[168:171], v[144:159]
    v_exp_f32 v52, v52
    v_exp_f32 v53, v53
    v_exp_f32 v54, v54
    v_exp_f32 v55, v55
    v_mfma_f32_32x32x16_bf16 v[144:159], a[204:207], v[172:175], v[144:159]
    v_exp_f32 v56, v56
    v_exp_f32 v57, v57
    v_exp_f32 v58, v58
    v_exp_f32 v59, v59
    v_mfma_f32_32x32x16_bf16 v[32:47], a[16:19], v[176:179], v[96:111]
    v_exp_f32 v60, v60
    v_exp_f32 v61, v61
    v_exp_f32 v62, v62
    v_exp_f32 v63, v63
    v_cvt_pk_bf16_f32 v160, v48, v49
    v_cvt_pk_bf16_f32 v161, v50, v51
    v_cvt_pk_bf16_f32 v162, v52, v53
    v_cvt_pk_bf16_f32 v163, v54, v55
    v_cvt_pk_bf16_f32 v164, v56, v57
    v_cvt_pk_bf16_f32 v165, v58, v59
    v_cvt_pk_bf16_f32 v166, v60, v61
    v_cvt_pk_bf16_f32 v167, v62, v63
    buffer_load_dwordx4 v25, s[20:23], s66 offen offset:2048 lds
    s_add_u32 s65, s65, s84
    s_add_u32 s66, s66, s85
    s_mov_b32 m0, s65
    v_exp_f32 v80, v80
    v_exp_f32 v81, v81
    v_exp_f32 v82, v82
    v_exp_f32 v83, v83
    v_mfma_f32_32x32x16_bf16 v[128:143], a[176:179], v[160:163], v[128:143]
    v_exp_f32 v84, v84
    v_exp_f32 v85, v85
    v_exp_f32 v86, v86
    v_exp_f32 v87, v87
    v_mfma_f32_32x32x16_bf16 v[128:143], a[180:183], v[164:167], v[128:143]
    v_exp_f32 v88, v88
    v_exp_f32 v89, v89
    v_exp_f32 v90, v90
    v_exp_f32 v91, v91
    v_mfma_f32_32x32x16_bf16 v[64:79], a[20:23], v[180:183], v[112:127]
    v_exp_f32 v92, v92
    v_exp_f32 v93, v93
    v_exp_f32 v94, v94
    v_exp_f32 v95, v95
    v_cvt_pk_bf16_f32 v168, v80, v81
    v_cvt_pk_bf16_f32 v169, v82, v83
    v_cvt_pk_bf16_f32 v170, v84, v85
    v_cvt_pk_bf16_f32 v171, v86, v87
    v_cvt_pk_bf16_f32 v172, v88, v89
    v_cvt_pk_bf16_f32 v173, v90, v91
    v_cvt_pk_bf16_f32 v174, v92, v93
    v_cvt_pk_bf16_f32 v175, v94, v95
    buffer_load_dwordx4 v4, s[20:23], s66 offen lds
    buffer_load_dwordx4 v24, s[20:23], s66 offen offset:1024 lds
    s_cmp_eq_u32 s47, 6
    s_cbranch_scc1 L_rare_58
L_back_59:
    v_exp_f32 v32, v32
    v_exp_f32 v33, v33
    v_exp_f32 v34, v34
    v_exp_f32 v35, v35
    v_mfma_f32_32x32x16_bf16 v[144:159], a[184:187], v[168:171], v[144:159]
    v_exp_f32 v36, v36
    v_exp_f32 v37, v37
    v_exp_f32 v38, v38
    v_exp_f32 v39, v39
    v_mfma_f32_32x32x16_bf16 v[144:159], a[188:191], v[172:175], v[144:159]
    v_exp_f32 v40, v40
    v_exp_f32 v41, v41
    v_exp_f32 v42, v42
    v_exp_f32 v43, v43
    v_mfma_f32_32x32x16_bf16 v[48:63], a[8:11], v[176:179], v[96:111]
    v_exp_f32 v44, v44
    v_exp_f32 v45, v45
    v_exp_f32 v46, v46
    v_exp_f32 v47, v47
    v_cvt_pk_bf16_f32 v160, v32, v33
    v_cvt_pk_bf16_f32 v161, v34, v35
    v_cvt_pk_bf16_f32 v162, v36, v37
    v_cvt_pk_bf16_f32 v163, v38, v39
    v_cvt_pk_bf16_f32 v164, v40, v41
    v_cvt_pk_bf16_f32 v165, v42, v43
    v_cvt_pk_bf16_f32 v166, v44, v45
    v_cvt_pk_bf16_f32 v167, v46, v47
    buffer_load_dwordx4 v25, s[20:23], s66 offen offset:2048 lds
    s_add_u32 s65, s65, s84
    s_add_u32 s66, s66, s85
    s_mov_b32 m0, s65
    v_exp_f32 v64, v64
    v_exp_f32 v65, v65
    v_exp_f32 v66, v66
    v_exp_f32 v67, v67
    v_mfma_f32_32x32x16_bf16 v[128:143], a[160:163], v[160:163], v[128:143]
    v_exp_f32 v68, v68
    v_exp_f32 v69, v69
    v_exp_f32 v70, v70
    v_exp_f32 v71, v71
    v_mfma_f32_32x32x16_bf16 v[128:143], a[164:167], v[164:167], v[128:143]
    v_exp_f32 v72, v72
    v_exp_f32 v73, v73
    v_exp_f32 v74, v74
    v_exp_f32 v75, v75
    v_mfma_f32_32x32x16_bf16 v[80:95], a[12:15], v[180:183], v[112:127]
    v_exp_f32 v76, v76
    v_exp_f32 v77, v77
    v_exp_f32 v78, v78
    v_exp_f32 v79, v79
    v_cvt_pk_bf16_f32 v168, v64, v65
    v_cvt_pk_bf16_f32 v169, v66, v67
    v_cvt_pk_bf16_f32 v170, v68, v69
    v_cvt_pk_bf16_f32 v171, v70, v71
    v_cvt_pk_bf16_f32 v172, v72, v73
    v_cvt_pk_bf16_f32 v173, v74, v75
    v_cvt_pk_bf16_f32 v174, v76, v77
    v_cvt_pk_bf16_f32 v175, v78, v79
    buffer_load_dwordx4 v4, s[20:23], s66 offen lds
    s_cmp_eq_u32 s47, 7
    s_cbranch_scc1 L_rare_60
L_back_61:
    v_exp_f32 v48, v48
    v_exp_f32 v49, v49
    v_exp_f32 v50, v50
    v_exp_f32 v51, v51
    v_mfma_f32_32x32x16_bf16 v[144:159], a[168:171], v[168:171], v[144:159]
    v_exp_f32 v52, v52
    v_exp_f32 v53, v53
    v_exp_f32 v54, v54
    v_exp_f32 v55, v55
    v_mfma_f32_32x32x16_bf16 v[144:159], a[172:175], v[172:175], v[144:159]
    v_exp_f32 v56, v56
    v_exp_f32 v57, v57
    v_exp_f32 v58, v58
    v_exp_f32 v59, v59
    v_mfma_f32_32x32x16_bf16 v[32:47], a[0:3], v[176:179], v[96:111]
    v_exp_f32 v60, v60
    v_exp_f32 v61, v61
    v_exp_f32 v62, v62
    v_exp_f32 v63, v63
    v_cvt_pk_bf16_f32 v160, v48, v49
    v_cvt_pk_bf16_f32 v161, v50, v51
    v_cvt_pk_bf16_f32 v162, v52, v53
    v_cvt_pk_bf16_f32 v163, v54, v55
    v_cvt_pk_bf16_f32 v164, v56, v57
    v_cvt_pk_bf16_f32 v165, v58, v59
    v_cvt_pk_bf16_f32 v166, v60, v61
    v_cvt_pk_bf16_f32 v167, v62, v63
    buffer_load_dwordx4 v24, s[20:23], s66 offen offset:1024 lds
    v_exp_f32 v80, v80
    v_exp_f32 v81, v81
    v_exp_f32 v82, v82
    v_exp_f32 v83, v83
    v_mfma_f32_32x32x16_bf16 v[128:143], a[144:147], v[160:163], v[128:143]
    v_exp_f32 v84, v84
    v_exp_f32 v85, v85
    v_exp_f32 v86, v86
    v_exp_f32 v87, v87
    v_mfma_f32_32x32x16_bf16 v[128:143], a[148:151], v[164:167], v[128:143]
    v_exp_f32 v88, v88
    v_exp_f32 v89, v89
    v_exp_f32 v90, v90
    v_exp_f32 v91, v91
    v_mfma_f32_32x32x16_bf16 v[64:79], a[4:7], v[180:183], v[112:127]
    v_exp_f32 v92, v92
    v_exp_f32 v93, v93
    v_exp_f32 v94, v94
    v_exp_f32 v95, v95
    v_cvt_pk_bf16_f32 v168, v80, v81
    v_cvt_pk_bf16_f32 v169, v82, v83
    v_cvt_pk_bf16_f32 v170, v84, v85
    v_cvt_pk_bf16_f32 v171, v86, v87
    v_cvt_pk_bf16_f32 v172, v88, v89
    v_cvt_pk_bf16_f32 v173, v90, v91
    v_cvt_pk_bf16_f32 v174, v92, v93
    v_cvt_pk_bf16_f32 v175, v94, v95
    buffer_load_dwordx4 v25, s[20:23], s66 offen offset:2048 lds
    v_exp_f32 v32, v32
    v_exp_f32 v33, v33
    v_exp_f32 v34, v34
    v_exp_f32 v35, v35
    v_mfma_f32_32x32x16_bf16 v[144:159], a[152:155], v[168:171], v[144:159]
    v_exp_f32 v36, v36
    v_exp_f32 v37, v37
    v_exp_f32 v38, v38
    v_exp_f32 v39, v39
    v_mfma_f32_32x32x16_bf16 v[144:159], a[156:159], v[172:175], v[144:159]
    v_exp_f32 v40, v40
    v_exp_f32 v41, v41
    v_exp_f32 v42, v42
    v_exp_f32 v43, v43
    v_exp_f32 v44, v44
    v_exp_f32 v45, v45
    v_exp_f32 v46, v46
    v_exp_f32 v47, v47
    v_cvt_pk_bf16_f32 v160, v32, v33
    v_cvt_pk_bf16_f32 v161, v34, v35
    v_cvt_pk_bf16_f32 v162, v36, v37
    v_cvt_pk_bf16_f32 v163, v38, v39
    v_cvt_pk_bf16_f32 v164, v40, v41
    v_cvt_pk_bf16_f32 v165, v42, v43
    v_cvt_pk_bf16_f32 v166, v44, v45
    v_cvt_pk_bf16_f32 v167, v46, v47
    v_bfi_b32 v160, v232, 0, v160
    v_bfi_b32 v161, v233, 0, v161
    v_bfi_b32 v162, v234, 0, v162
    v_bfi_b32 v163, v235, 0, v163
    v_bfi_b32 v164, v236, 0, v164
    v_bfi_b32 v165, v237, 0, v165
    v_bfi_b32 v166, v238, 0, v166
    v_bfi_b32 v167, v239, 0, v167
    v_exp_f32 v64, v64
    v_exp_f32 v65, v65
    v_exp_f32 v66, v66
    v_exp_f32 v67, v67
    v_mfma_f32_32x32x16_bf16 v[128:143], a[128:131], v[160:163], v[128:143]
    v_exp_f32 v68, v68
    v_exp_f32 v69, v69
    v_exp_f32 v70, v70
    v_exp_f32 v71, v71
    v_mfma_f32_32x32x16_bf16 v[128:143], a[132:135], v[164:167], v[128:143]
    v_exp_f32 v72, v72
    v_exp_f32 v73, v73
    v_exp_f32 v74, v74
    v_exp_f32 v75, v75
    v_exp_f32 v76, v76
    v_exp_f32 v77, v77
    v_exp_f32 v78, v78
    v_exp_f32 v79, v79
    v_cvt_pk_bf16_f32 v168, v64, v65
    v_cvt_pk_bf16_f32 v169, v66, v67
    v_cvt_pk_bf16_f32 v170, v68, v69
    v_cvt_pk_bf16_f32 v171, v70, v71
    v_cvt_pk_bf16_f32 v172, v72, v73
    v_cvt_pk_bf16_f32 v173, v74, v75
    v_cvt_pk_bf16_f32 v174, v76, v77
    v_cvt_pk_bf16_f32 v175, v78, v79
    v_bfi_b32 v168, v232, 0, v168
    v_bfi_b32 v169, v233, 0, v169
    v_bfi_b32 v170, v234, 0, v170
    v_bfi_b32 v171, v235, 0, v171
    v_bfi_b32 v172, v236, 0, v172
    v_bfi_b32 v173, v237, 0, v173
    v_bfi_b32 v174, v238, 0, v174
    v_bfi_b32 v175, v239, 0, v175
    v_mfma_f32_32x32x16_bf16 v[144:159], a[136:139], v[168:171], v[144:159]
    s_nop 0
    v_mfma_f32_32x32x16_bf16 v[144:159], a[140:143], v[172:175], v[144:159]
    v_rcp_f32 v184, v136
    s_nop 0
    v_mul_f32 v128, v128, v184
    v_mul_f32 v129, v129, v184
    v_mul_f32 v130, v130, v184
    v_mul_f32 v131, v131, v184
    v_mul_f32 v132, v132, v184
    v_mul_f32 v133, v133, v184
    v_mul_f32 v134, v134, v184
    v_mul_f32 v135, v135, v184
    v_cvt_pk_bf16_f32 v160, v128, v129
    v_cvt_pk_bf16_f32 v161, v130, v131
    v_cvt_pk_bf16_f32 v162, v132, v133
    v_cvt_pk_bf16_f32 v163, v134, v135
    v_rcp_f32 v186, v152
    s_nop 0
    v_mul_f32 v144, v144, v186
    v_mul_f32 v145, v145, v186
    v_mul_f32 v146, v146, v186
    v_mul_f32 v147, v147, v186
    v_mul_f32 v148, v148, v186
    v_mul_f32 v149, v149, v186
    v_mul_f32 v150, v150, v186
    v_mul_f32 v151, v151, v186
    v_cvt_pk_bf16_f32 v168, v144, v145
    v_cvt_pk_bf16_f32 v169, v146, v147
    v_cvt_pk_bf16_f32 v170, v148, v149
    v_cvt_pk_bf16_f32 v171, v150, v151
    s_lshl_b32 s59, s47, 15
    s_lshl_b32 s60, s45, 11
    s_add_u32 s59, s59, s60
    s_add_u32 s59, s59, s92
    s_cmp_eq_u32 s49, 1
    s_cbranch_scc0 L_ss_62
    buffer_store_dwordx4 v[160:163], v2, s[40:43], s59 offen
    buffer_store_dwordx4 v[168:171], v2, s[40:43], s59 offen offset:1024
    s_branch L_se_63
L_ss_62:
    buffer_store_dwordx4 v[160:163], v2, s[40:43], s59 offen sc1
    buffer_store_dwordx4 v[168:171], v2, s[40:43], s59 offen offset:1024 sc1
L_se_63:
    s_waitcnt vmcnt(0)
    s_lshl_b32 s57, s44, 9
    s_add_u32 s57, s57, 19931136
    s_lshl_b32 s58, s45, 2
    s_add_u32 s58, s58, s46
    s_lshl_b32 s58, s58, 3
    s_add_u32 s58, s58, s57
    v_mov_b32 v12, s48
    v_mov_b32 v13, 0
    s_mov_b64 exec, 1
    s_cmp_eq_u32 s49, 1
    s_cbranch_scc0 L_fs_64
    buffer_store_dword v12, v13, s[40:43], s58 offen
    s_branch L_fe_65
L_fs_64:
    buffer_store_dword v12, v13, s[40:43], s58 offen sc1
L_fe_65:
    s_mov_b64 exec, -1
    s_cmp_eq_u32 s46, 0
    s_cbranch_scc1 L_w0_66
    s_branch L_we_67
L_w0_66:
    v_lshlrev_b32 v12, 3, v1
    s_mov_b32 s67, 0
L_poll_68:
    buffer_load_dword v13, v12, s[40:43], s57 offen sc1
    s_waitcnt vmcnt(0)
    v_cmp_eq_u32 vcc, s48, v13
    s_add_u32 s67, s67, 1
    s_cmp_gt_u32 s67, 400000
    s_cbranch_scc1 L_polld_69
    s_cmp_eq_u64 vcc, -1
    s_cbranch_scc0 L_poll_68
L_polld_69:
    s_cmp_gt_u32 s67, 400000
    s_cselect_b32 s56, 1, 0
    s_or_b32 s69, s69, s56
L_we_67:
    s_barrier
    s_mul_i32 s89, s51, 32768
    s_mul_i32 s57, s52, 16384
    s_add_u32 s89, s89, s57
    s_mul_i32 s57, s92, 1
    s_add_u32 s89, s89, s57
    s_add_u32 s90, s89, 0
    buffer_load_dwordx4 a[0:3], v2, s[40:43], s90 offen sc1
    buffer_load_dwordx4 a[4:7], v2, s[40:43], s90 offen offset:1024 sc1
    buffer_load_dwordx4 a[8:11], v2, s[40:43], s90 offen offset:2048 sc1
    buffer_load_dwordx4 a[12:15], v2, s[40:43], s90 offen offset:3072 sc1
    s_add_u32 s90, s89, 4096
    buffer_load_dwordx4 a[16:19], v2, s[40:43], s90 offen sc1
    buffer_load_dwordx4 a[20:23], v2, s[40:43], s90 offen offset:1024 sc1
    buffer_load_dwordx4 a[24:27], v2, s[40:43], s90 offen offset:2048 sc1
    buffer_load_dwordx4 a[28:31], v2, s[40:43], s90 offen offset:3072 sc1
    s_add_u32 s90, s89, 8192
    buffer_load_dwordx4 a[32:35], v2, s[40:43], s90 offen sc1
    buffer_load_dwordx4 a[36:39], v2, s[40:43], s90 offen offset:1024 sc1
    buffer_load_dwordx4 a[40:43], v2, s[40:43], s90 offen offset:2048 sc1
    buffer_load_dwordx4 a[44:47], v2, s[40:43], s90 offen offset:3072 sc1
    v_lshrrev_b32 v12, 5, v1
    v_lshlrev_b32 v12, 2, v12
    v_bfe_u32 v13, v1, 2, 2
    v_add_u32 v12, v12, v13
    v_lshlrev_b32 v12, 7, v12
    v_lshrrev_b32 v13, 1, v13
    v_xor_b32 v13, s52, v13
    v_lshl_add_u32 v12, v13, 6, v12
    v_bfe_u32 v13, v1, 4, 1
    v_lshl_add_u32 v12, v13, 5, v12
    v_and_b32 v13, 3, v1
    v_lshl_add_u32 v6, v13, 3, v12
    v_xor_b32 v7, 64, v6
    s_lshl_b32 s56, s52, 15
    s_add_u32 s56, s56, 98304
    v_add_u32 v6, s56, v6
    v_add_u32 v7, s56, v7
    ds_read_b64_tr_b16 v[64:65], v6 offset:0
    ds_read_b64_tr_b16 v[66:67], v6 offset:1024
    ds_read_b64_tr_b16 v[68:69], v7 offset:0
    ds_read_b64_tr_b16 v[70:71], v7 offset:1024
    ds_read_b64_tr_b16 v[72:73], v6 offset:2048
    ds_read_b64_tr_b16 v[74:75], v6 offset:3072
    ds_read_b64_tr_b16 v[76:77], v7 offset:2048
    ds_read_b64_tr_b16 v[78:79], v7 offset:3072
    s_waitcnt vmcnt(11)
    s_waitcnt lgkmcnt(4)
    v_mfma_f32_32x32x16_bf16 v[32:47], v[64:67], a[0:3], 0
    ds_read_b64_tr_b16 v[80:81], v6 offset:4096
    ds_read_b64_tr_b16 v[82:83], v6 offset:5120
    s_add_u32 s90, s89, 12288
    buffer_load_dwordx4 a[48:51], v2, s[40:43], s90 offen sc1
    v_mfma_f32_32x32x16_bf16 v[48:63], v[68:71], a[0:3], 0
    ds_read_b64_tr_b16 v[84:85], v7 offset:4096
    ds_read_b64_tr_b16 v[86:87], v7 offset:5120
    s_waitcnt vmcnt(11)
    s_waitcnt lgkmcnt(4)
    v_mfma_f32_32x32x16_bf16 v[32:47], v[72:75], a[4:7], v[32:47]
    ds_read_b64_tr_b16 v[64:65], v6 offset:6144
    ds_read_b64_tr_b16 v[66:67], v6 offset:7168
    buffer_load_dwordx4 a[52:55], v2, s[40:43], s90 offen offset:1024 sc1
    v_mfma_f32_32x32x16_bf16 v[48:63], v[76:79], a[4:7], v[48:63]
    ds_read_b64_tr_b16 v[68:69], v7 offset:6144
    ds_read_b64_tr_b16 v[70:71], v7 offset:7168
    s_waitcnt vmcnt(11)
    s_waitcnt lgkmcnt(4)
    v_mfma_f32_32x32x16_bf16 v[32:47], v[80:83], a[8:11], v[32:47]
    ds_read_b64_tr_b16 v[72:73], v6 offset:8192
    ds_read_b64_tr_b16 v[74:75], v6 offset:9216
    buffer_load_dwordx4 a[56:59], v2, s[40:43], s90 offen offset:2048 sc1
    v_mfma_f32_32x32x16_bf16 v[48:63], v[84:87], a[8:11], v[48:63]
    ds_read_b64_tr_b16 v[76:77], v7 offset:8192
    ds_read_b64_tr_b16 v[78:79], v7 offset:9216
    s_waitcnt vmcnt(11)
    s_waitcnt lgkmcnt(4)
    v_mfma_f32_32x32x16_bf16 v[32:47], v[64:67], a[12:15], v[32:47]
    ds_read_b64_tr_b16 v[80:81], v6 offset:10240
    ds_read_b64_tr_b16 v[82:83], v6 offset:11264
    buffer_load_dwordx4 a[60:63], v2, s[40:43], s90 offen offset:3072 sc1
    v_mfma_f32_32x32x16_bf16 v[48:63], v[68:71], a[12:15], v[48:63]
    ds_read_b64_tr_b16 v[84:85], v7 offset:10240
    ds_read_b64_tr_b16 v[86:87], v7 offset:11264
    s_waitcnt vmcnt(11)
    s_waitcnt lgkmcnt(4)
    v_mfma_f32_32x32x16_bf16 v[32:47], v[72:75], a[16:19], v[32:47]
    ds_read_b64_tr_b16 v[64:65], v6 offset:12288
    ds_read_b64_tr_b16 v[66:67], v6 offset:13312
    v_mfma_f32_32x32x16_bf16 v[48:63], v[76:79], a[16:19], v[48:63]
    ds_read_b64_tr_b16 v[68:69], v7 offset:12288
    ds_read_b64_tr_b16 v[70:71], v7 offset:13312
    s_waitcnt vmcnt(10)
    s_waitcnt lgkmcnt(4)
    v_mfma_f32_32x32x16_bf16 v[32:47], v[80:83], a[20:23], v[32:47]
    ds_read_b64_tr_b16 v[72:73], v6 offset:14336
    ds_read_b64_tr_b16 v[74:75], v6 offset:15360
    v_mfma_f32_32x32x16_bf16 v[48:63], v[84:87], a[20:23], v[48:63]
    ds_read_b64_tr_b16 v[76:77], v7 offset:14336
    ds_read_b64_tr_b16 v[78:79], v7 offset:15360
    s_waitcnt vmcnt(9)
    s_waitcnt lgkmcnt(4)
    v_mfma_f32_32x32x16_bf16 v[32:47], v[64:67], a[24:27], v[32:47]
    ds_read_b64_tr_b16 v[80:81], v6 offset:16384
    ds_read_b64_tr_b16 v[82:83], v6 offset:17408
    v_mfma_f32_32x32x16_bf16 v[48:63], v[68:71], a[24:27], v[48:63]
    ds_read_b64_tr_b16 v[84:85], v7 offset:16384
    ds_read_b64_tr_b16 v[86:87], v7 offset:17408
    s_waitcnt vmcnt(8)
    s_waitcnt lgkmcnt(4)
    v_mfma_f32_32x32x16_bf16 v[32:47], v[72:75], a[28:31], v[32:47]
    ds_read_b64_tr_b16 v[64:65], v6 offset:18432
    ds_read_b64_tr_b16 v[66:67], v6 offset:19456
    v_mfma_f32_32x32x16_bf16 v[48:63], v[76:79], a[28:31], v[48:63]
    ds_read_b64_tr_b16 v[68:69], v7 offset:18432
    ds_read_b64_tr_b16 v[70:71], v7 offset:19456
    s_waitcnt vmcnt(7)
    s_waitcnt lgkmcnt(4)
    v_mfma_f32_32x32x16_bf16 v[32:47], v[80:83], a[32:35], v[32:47]
    ds_read_b64_tr_b16 v[72:73], v6 offset:20480
    ds_read_b64_tr_b16 v[74:75], v6 offset:21504
    v_mfma_f32_32x32x16_bf16 v[48:63], v[84:87], a[32:35], v[48:63]
    ds_read_b64_tr_b16 v[76:77], v7 offset:20480
    ds_read_b64_tr_b16 v[78:79], v7 offset:21504
    s_waitcnt vmcnt(6)
    s_waitcnt lgkmcnt(4)
    v_mfma_f32_32x32x16_bf16 v[32:47], v[64:67], a[36:39], v[32:47]
    ds_read_b64_tr_b16 v[80:81], v6 offset:22528
    ds_read_b64_tr_b16 v[82:83], v6 offset:23552
    v_mfma_f32_32x32x16_bf16 v[48:63], v[68:71], a[36:39], v[48:63]
    ds_read_b64_tr_b16 v[84:85], v7 offset:22528
    ds_read_b64_tr_b16 v[86:87], v7 offset:23552
    s_waitcnt vmcnt(5)
    s_waitcnt lgkmcnt(4)
    v_mfma_f32_32x32x16_bf16 v[32:47], v[72:75], a[40:43], v[32:47]
    ds_read_b64_tr_b16 v[64:65], v6 offset:24576
    ds_read_b64_tr_b16 v[66:67], v6 offset:25600
    v_mfma_f32_32x32x16_bf16 v[48:63], v[76:79], a[40:43], v[48:63]
    ds_read_b64_tr_b16 v[68:69], v7 offset:24576
    ds_read_b64_tr_b16 v[70:71], v7 offset:25600
    s_waitcnt vmcnt(4)
    s_waitcnt lgkmcnt(4)
    v_mfma_f32_32x32x16_bf16 v[32:47], v[80:83], a[44:47], v[32:47]
    ds_read_b64_tr_b16 v[72:73], v6 offset:26624
    ds_read_b64_tr_b16 v[74:75], v6 offset:27648
    v_mfma_f32_32x32x16_bf16 v[48:63], v[84:87], a[44:47], v[48:63]
    ds_read_b64_tr_b16 v[76:77], v7 offset:26624
    ds_read_b64_tr_b16 v[78:79], v7 offset:27648
    s_waitcnt vmcnt(3)
    s_waitcnt lgkmcnt(4)
    v_mfma_f32_32x32x16_bf16 v[32:47], v[64:67], a[48:51], v[32:47]
    ds_read_b64_tr_b16 v[80:81], v6 offset:28672
    ds_read_b64_tr_b16 v[82:83], v6 offset:29696
    v_mfma_f32_32x32x16_bf16 v[48:63], v[68:71], a[48:51], v[48:63]
    ds_read_b64_tr_b16 v[84:85], v7 offset:28672
    ds_read_b64_tr_b16 v[86:87], v7 offset:29696
    s_waitcnt vmcnt(2)
    s_waitcnt lgkmcnt(4)
    v_mfma_f32_32x32x16_bf16 v[32:47], v[72:75], a[52:55], v[32:47]
    ds_read_b64_tr_b16 v[64:65], v6 offset:30720
    ds_read_b64_tr_b16 v[66:67], v6 offset:31744
    v_mfma_f32_32x32x16_bf16 v[48:63], v[76:79], a[52:55], v[48:63]
    ds_read_b64_tr_b16 v[68:69], v7 offset:30720
    ds_read_b64_tr_b16 v[70:71], v7 offset:31744
    s_waitcnt vmcnt(1)
    s_waitcnt lgkmcnt(4)
    v_mfma_f32_32x32x16_bf16 v[32:47], v[80:83], a[56:59], v[32:47]
    v_mfma_f32_32x32x16_bf16 v[48:63], v[84:87], a[56:59], v[48:63]
    s_waitcnt vmcnt(0)
    s_waitcnt lgkmcnt(0)
    v_mfma_f32_32x32x16_bf16 v[32:47], v[64:67], a[60:63], v[32:47]
    v_mfma_f32_32x32x16_bf16 v[48:63], v[68:71], a[60:63], v[48:63]
    s_barrier
    s_lshl_b32 s56, s46, 12
    s_add_u32 s56, s56, 147456
    v_add_u32 v12, s56, v2
    v_xor_b32 v13, 8192, v12
    s_nop 6
    ds_write_b128 v12, v[48:51] offset:0
    ds_write_b128 v12, v[52:55] offset:1024
    ds_write_b128 v12, v[56:59] offset:2048
    ds_write_b128 v12, v[60:63] offset:3072
    s_waitcnt lgkmcnt(0)
    s_barrier
    ds_read_b128 v[48:51], v13 offset:0
    ds_read_b128 v[52:55], v13 offset:1024
    ds_read_b128 v[56:59], v13 offset:2048
    ds_read_b128 v[60:63], v13 offset:3072
    s_waitcnt lgkmcnt(0)
    v_add_f32 v32, v32, v48
    v_add_f32 v33, v33, v49
    v_add_f32 v34, v34, v50
    v_add_f32 v35, v35, v51
    v_add_f32 v36, v36, v52
    v_add_f32 v37, v37, v53
    v_add_f32 v38, v38, v54
    v_add_f32 v39, v39, v55
    v_add_f32 v40, v40, v56
    v_add_f32 v41, v41, v57
    v_add_f32 v42, v42, v58
    v_add_f32 v43, v43, v59
    v_add_f32 v44, v44, v60
    v_add_f32 v45, v45, v61
    v_add_f32 v46, v46, v62
    v_add_f32 v47, v47, v63
    v_permlane32_swap_b32 v192, v194
    v_permlane32_swap_b32 v193, v195
    v_permlane32_swap_b32 v196, v198
    v_permlane32_swap_b32 v197, v199
    v_lshlrev_b32 v64, 16, v192
    v_and_b32 v65, 0xffff0000, v192
    v_lshlrev_b32 v66, 16, v193
    v_and_b32 v67, 0xffff0000, v193
    v_lshlrev_b32 v68, 16, v194
    v_and_b32 v69, 0xffff0000, v194
    v_lshlrev_b32 v70, 16, v195
    v_and_b32 v71, 0xffff0000, v195
    v_lshlrev_b32 v72, 16, v196
    v_and_b32 v73, 0xffff0000, v196
    v_lshlrev_b32 v74, 16, v197
    v_and_b32 v75, 0xffff0000, v197
    v_lshlrev_b32 v76, 16, v198
    v_and_b32 v77, 0xffff0000, v198
    v_lshlrev_b32 v78, 16, v199
    v_and_b32 v79, 0xffff0000, v199
    v_add_f32 v32, v32, v64
    v_add_f32 v33, v33, v65
    v_add_f32 v34, v34, v66
    v_add_f32 v35, v35, v67
    v_add_f32 v36, v36, v68
    v_add_f32 v37, v37, v69
    v_add_f32 v38, v38, v70
    v_add_f32 v39, v39, v71
    v_add_f32 v40, v40, v72
    v_add_f32 v41, v41, v73
    v_add_f32 v42, v42, v74
    v_add_f32 v43, v43, v75
    v_add_f32 v44, v44, v76
    v_add_f32 v45, v45, v77
    v_add_f32 v46, v46, v78
    v_add_f32 v47, v47, v79
    v_add_f32 v64, v32, v33
    v_mul_f32 v65, v32, v32
    v_add_f32 v66, v34, v35
    v_mul_f32 v67, v33, v33
    v_fmac_f32 v65, v34, v34
    v_fmac_f32 v67, v35, v35
    v_add_f32 v64, v64, v36
    v_fmac_f32 v65, v36, v36
    v_add_f32 v66, v66, v37
    v_fmac_f32 v67, v37, v37
    v_add_f32 v64, v64, v38
    v_fmac_f32 v65, v38, v38
    v_add_f32 v66, v66, v39
    v_fmac_f32 v67, v39, v39
    v_add_f32 v64, v64, v40
    v_fmac_f32 v65, v40, v40
    v_add_f32 v66, v66, v41
    v_fmac_f32 v67, v41, v41
    v_add_f32 v64, v64, v42
    v_fmac_f32 v65, v42, v42
    v_add_f32 v66, v66, v43
    v_fmac_f32 v67, v43, v43
    v_add_f32 v64, v64, v44
    v_fmac_f32 v65, v44, v44
    v_add_f32 v66, v66, v45
    v_fmac_f32 v67, v45, v45
    v_add_f32 v64, v64, v46
    v_fmac_f32 v65, v46, v46
    v_add_f32 v66, v66, v47
    v_fmac_f32 v67, v47, v47
    v_add_f32 v64, v64, v66
    v_add_f32 v65, v65, v67
    v_mov_b32 v66, v64
    v_mov_b32 v67, v65
    s_nop 0
    v_permlane32_swap_b32 v64, v66
    v_permlane32_swap_b32 v65, v67
    v_add_f32 v64, v64, v66
    v_add_f32 v65, v65, v67
    v_lshlrev_b32 v66, 3, v1
    s_lshl_b32 s59, s51, 12
    s_lshl_b32 s60, s54, 8
    s_add_u32 s60, s60, s59
    s_add_u32 s60, s60, 18874368
    s_mov_b32 exec_hi, 0
    s_cmp_eq_u32 s49, 1
    s_cbranch_scc0 L_ss_70
    buffer_store_dwordx2 v[64:65], v66, s[40:43], s60 offen
    s_branch L_se_71
L_ss_70:
    buffer_store_dwordx2 v[64:65], v66, s[40:43], s60 offen sc1
L_se_71:
    s_mov_b64 exec, -1
    v_accvgpr_write_b32 a128, v32
    v_accvgpr_write_b32 a129, v33
    v_accvgpr_write_b32 a130, v34
    v_accvgpr_write_b32 a131, v35
    v_accvgpr_write_b32 a132, v36
    v_accvgpr_write_b32 a133, v37
    v_accvgpr_write_b32 a134, v38
    v_accvgpr_write_b32 a135, v39
    v_accvgpr_write_b32 a136, v40
    v_accvgpr_write_b32 a137, v41
    v_accvgpr_write_b32 a138, v42
    v_accvgpr_write_b32 a139, v43
    v_accvgpr_write_b32 a140, v44
    v_accvgpr_write_b32 a141, v45
    v_accvgpr_write_b32 a142, v46
    v_accvgpr_write_b32 a143, v47
    s_waitcnt vmcnt(0)
    s_lshl_b32 s57, s44, 9
    s_add_u32 s57, s57, 19939328
    s_lshl_b32 s58, s45, 2
    s_add_u32 s58, s58, s46
    s_lshl_b32 s58, s58, 3
    s_add_u32 s58, s58, s57
    v_mov_b32 v12, s48
    v_mov_b32 v13, 0
    s_mov_b64 exec, 1
    s_cmp_eq_u32 s49, 1
    s_cbranch_scc0 L_fs_72
    buffer_store_dword v12, v13, s[40:43], s58 offen
    s_branch L_fe_73
L_fs_72:
    buffer_store_dword v12, v13, s[40:43], s58 offen sc1
L_fe_73:
    s_mov_b64 exec, -1
    s_cmp_eq_u32 s46, 0
    s_cbranch_scc1 L_w0_74
    s_branch L_we_75
L_w0_74:
    v_lshlrev_b32 v12, 3, v1
    s_mov_b32 s67, 0
L_poll_76:
    buffer_load_dword v13, v12, s[40:43], s57 offen sc1
    s_waitcnt vmcnt(0)
    v_cmp_eq_u32 vcc, s48, v13
    s_add_u32 s67, s67, 1
    s_cmp_gt_u32 s67, 400000
    s_cbranch_scc1 L_polld_77
    s_cmp_eq_u64 vcc, -1
    s_cbranch_scc0 L_poll_76
L_polld_77:
    s_cmp_gt_u32 s67, 400000
    s_cselect_b32 s56, 1, 0
    s_or_b32 s69, s69, s56
L_we_75:
    s_barrier
    v_and_b32 v66, 31, v1
    v_lshlrev_b32 v66, 3, v66
    v_lshrrev_b32 v67, 5, v1
    v_lshl_add_u32 v66, v67, 11, v66
    s_lshl_b32 s59, s51, 12
    s_add_u32 s59, s59, 18874368
    buffer_load_dwordx2 v[68:69], v66, s[40:43], s59 offen sc1
    buffer_load_dwordx2 v[70:71], v66, s[40:43], s59 offen offset:256 sc1
    buffer_load_dwordx2 v[72:73], v66, s[40:43], s59 offen offset:512 sc1
    buffer_load_dwordx2 v[74:75], v66, s[40:43], s59 offen offset:768 sc1
    buffer_load_dwordx2 v[76:77], v66, s[40:43], s59 offen offset:1024 sc1
    buffer_load_dwordx2 v[78:79], v66, s[40:43], s59 offen offset:1280 sc1
    buffer_load_dwordx2 v[80:81], v66, s[40:43], s59 offen offset:1536 sc1
    buffer_load_dwordx2 v[82:83], v66, s[40:43], s59 offen offset:1792 sc1
    s_waitcnt vmcnt(0)
    v_add_f32 v68, v68, v72
    v_add_f32 v69, v69, v73
    v_add_f32 v70, v70, v74
    v_add_f32 v71, v71, v75
    v_add_f32 v68, v68, v76
    v_add_f32 v69, v69, v77
    v_add_f32 v70, v70, v78
    v_add_f32 v71, v71, v79
    v_add_f32 v68, v68, v80
    v_add_f32 v69, v69, v81
    v_add_f32 v70, v70, v82
    v_add_f32 v71, v71, v83
    v_add_f32 v68, v68, v70
    v_add_f32 v69, v69, v71
    v_mov_b32 v70, v68
    v_mov_b32 v71, v69
    s_nop 0
    v_permlane32_swap_b32 v68, v70
    v_permlane32_swap_b32 v69, v71
    v_add_f32 v68, v68, v70
    v_add_f32 v69, v69, v71
    v_mov_b32 v72, 0x3b000000
    v_mul_f32 v68, v68, v72
    v_mul_f32 v69, v69, v72
    v_fma_f32 v69, -v68, v68, v69
    v_max_f32 v69, 0, v69
    v_add_f32 v69, 0x3727c5ac, v69
    v_rsq_f32 v69, v69
    s_nop 0
    v_mul_f32 v70, v68, v69
    v_sub_f32 v70, 0, v70
    v_fma_f32 v32, v32, v69, v70
    v_fma_f32 v33, v33, v69, v70
    v_fma_f32 v34, v34, v69, v70
    v_fma_f32 v35, v35, v69, v70
    v_fma_f32 v36, v36, v69, v70
    v_fma_f32 v37, v37, v69, v70
    v_fma_f32 v38, v38, v69, v70
    v_fma_f32 v39, v39, v69, v70
    v_fma_f32 v40, v40, v69, v70
    v_fma_f32 v41, v41, v69, v70
    v_fma_f32 v42, v42, v69, v70
    v_fma_f32 v43, v43, v69, v70
    v_fma_f32 v44, v44, v69, v70
    v_fma_f32 v45, v45, v69, v70
    v_fma_f32 v46, v46, v69, v70
    v_fma_f32 v47, v47, v69, v70
    v_cvt_pk_bf16_f32 v64, v32, v33
    v_cvt_pk_bf16_f32 v65, v34, v35
    v_cvt_pk_bf16_f32 v66, v36, v37
    v_cvt_pk_bf16_f32 v67, v38, v39
    v_cvt_pk_bf16_f32 v68, v40, v41
    v_cvt_pk_bf16_f32 v69, v42, v43
    v_cvt_pk_bf16_f32 v70, v44, v45
    v_cvt_pk_bf16_f32 v71, v46, v47
    s_lshl_b32 s59, s51, 15
    s_lshl_b32 s60, s54, 11
    s_add_u32 s59, s59, s60
    s_add_u32 s59, s59, s92
    s_cmp_eq_u32 s49, 1
    s_cbranch_scc0 L_ss_78
    buffer_store_dwordx4 v[64:67], v2, s[40:43], s59 offen
    buffer_store_dwordx4 v[68:71], v2, s[40:43], s59 offen offset:1024
    s_branch L_se_79
L_ss_78:
    buffer_store_dwordx4 v[64:67], v2, s[40:43], s59 offen sc1
    buffer_store_dwordx4 v[68:71], v2, s[40:43], s59 offen offset:1024 sc1
L_se_79:
    s_waitcnt vmcnt(0)
    s_lshl_b32 s57, s44, 9
    s_add_u32 s57, s57, 19947520
    s_lshl_b32 s58, s45, 2
    s_add_u32 s58, s58, s46
    s_lshl_b32 s58, s58, 3
    s_add_u32 s58, s58, s57
    v_mov_b32 v12, s48
    v_mov_b32 v13, 0
    s_mov_b64 exec, 1
    s_cmp_eq_u32 s49, 1
    s_cbranch_scc0 L_fs_80
    buffer_store_dword v12, v13, s[40:43], s58 offen
    s_branch L_fe_81
L_fs_80:
    buffer_store_dword v12, v13, s[40:43], s58 offen sc1
L_fe_81:
    s_mov_b64 exec, -1
    s_cmp_eq_u32 s46, 0
    s_cbranch_scc1 L_w0_82
    s_branch L_we_83
L_w0_82:
    v_lshlrev_b32 v12, 3, v1
    s_mov_b32 s67, 0
L_poll_84:
    buffer_load_dword v13, v12, s[40:43], s57 offen sc1
    s_waitcnt vmcnt(0)
    v_cmp_eq_u32 vcc, s48, v13
    s_add_u32 s67, s67, 1
    s_cmp_gt_u32 s67, 400000
    s_cbranch_scc1 L_polld_85
    s_cmp_eq_u64 vcc, -1
    s_cbranch_scc0 L_poll_84
L_polld_85:
    s_cmp_gt_u32 s67, 400000
    s_cselect_b32 s56, 1, 0
    s_or_b32 s69, s69, s56
L_we_83:
    s_barrier
    s_mul_i32 s89, s47, 32768
    s_mul_i32 s57, s92, 1
    s_add_u32 s89, s89, s57
    s_add_u32 s90, s89, 0
    buffer_load_dwordx4 a[0:3], v2, s[40:43], s90 offen sc1
    buffer_load_dwordx4 a[4:7], v2, s[40:43], s90 offen offset:1024 sc1
    buffer_load_dwordx4 a[8:11], v2, s[40:43], s90 offen offset:2048 sc1
    buffer_load_dwordx4 a[12:15], v2, s[40:43], s90 offen offset:3072 sc1
    s_add_u32 s90, s89, 4096
    buffer_load_dwordx4 a[16:19], v2, s[40:43], s90 offen sc1
    buffer_load_dwordx4 a[20:23], v2, s[40:43], s90 offen offset:1024 sc1
    buffer_load_dwordx4 a[24:27], v2, s[40:43], s90 offen offset:2048 sc1
    buffer_load_dwordx4 a[28:31], v2, s[40:43], s90 offen offset:3072 sc1
    s_add_u32 s90, s89, 8192
    buffer_load_dwordx4 a[32:35], v2, s[40:43], s90 offen sc1
    v_lshrrev_b32 v12, 5, v1
    v_lshlrev_b32 v12, 2, v12
    v_bfe_u32 v13, v1, 2, 2
    v_add_u32 v12, v12, v13
    v_mul_u32_u24 v12, 192, v12
    v_bfe_u32 v13, v1, 4, 1
    v_lshl_add_u32 v12, v13, 5, v12
    v_and_b32 v13, 3, v1
    v_lshl_add_u32 v6, v13, 3, v12
    v_add_u32 v7, 65536, v6
    v_add_u32 v8, 131072, v6
    v_mov_b32 v28, 0xc0135761
    v_mov_b32 v29, 0xbdd2d3e8
    s_mov_b32 s64, s46
    ds_read_b64_tr_b16 v[144:145], v6 offset:49152
    ds_read_b64_tr_b16 v[146:147], v6 offset:50688
    ds_read_b64_tr_b16 v[148:149], v6 offset:0
    ds_read_b64_tr_b16 v[150:151], v6 offset:1536
    ds_read_b64_tr_b16 v[152:153], v6 offset:49216
    ds_read_b64_tr_b16 v[154:155], v6 offset:50752
    ds_read_b64_tr_b16 v[156:157], v6 offset:64
    ds_read_b64_tr_b16 v[158:159], v6 offset:1600
    ds_read_b64_tr_b16 v[160:161], v6 offset:49280
    ds_read_b64_tr_b16 v[162:163], v6 offset:50816
    ds_read_b64_tr_b16 v[164:165], v6 offset:128
    ds_read_b64_tr_b16 v[166:167], v6 offset:1664
    ds_read_b64_tr_b16 v[168:169], v6 offset:52224
    ds_read_b64_tr_b16 v[170:171], v6 offset:53760
    ds_read_b64_tr_b16 v[172:173], v6 offset:3072
    ds_read_b64_tr_b16 v[174:175], v6 offset:4608
    ds_read_b64_tr_b16 v[176:177], v6 offset:52288
    ds_read_b64_tr_b16 v[178:179], v6 offset:53824
    ds_read_b64_tr_b16 v[180:181], v6 offset:3136
    ds_read_b64_tr_b16 v[182:183], v6 offset:4672
    ds_read_b64_tr_b16 v[184:185], v6 offset:52352
    ds_read_b64_tr_b16 v[186:187], v6 offset:53888
    ds_read_b64_tr_b16 v[188:189], v6 offset:3200
    ds_read_b64_tr_b16 v[190:191], v6 offset:4736
    s_waitcnt vmcnt(8)
    s_waitcnt lgkmcnt(12)
    v_mfma_f32_32x32x16_bf16 v[32:47], v[144:147], a[0:3], 0
    ds_read_b64_tr_b16 v[192:193], v6 offset:55296
    ds_read_b64_tr_b16 v[194:195], v6 offset:56832
    buffer_load_dwordx4 a[36:39], v2, s[40:43], s90 offen offset:1024 sc1
    s_mul_i32 s56, s64, 3
    s_min_u32 s56, s56, 7
    s_mul_i32 s57, s82, 2
    s_add_u32 s56, s56, s57
    s_mul_i32 s84, s83, 3072
    s_mul_i32 s85, s83, 44032
    s_mul_i32 s65, s56, 3072
    s_add_u32 s65, s65, 98304
    s_mul_i32 s66, s56, 44032
    s_add_u32 s66, s66, s88
    s_add_u32 s66, s66, 704512
    s_mov_b32 m0, s65
    s_nop 0
    buffer_load_dwordx4 v4, s[20:23], s66 offen lds
    v_mfma_f32_32x32x16_bf16 v[48:63], v[148:151], a[0:3], 0
    ds_read_b64_tr_b16 v[196:197], v6 offset:6144
    ds_read_b64_tr_b16 v[198:199], v6 offset:7680
    v_mfma_f32_32x32x16_bf16 v[64:79], v[152:155], a[0:3], 0
    ds_read_b64_tr_b16 v[200:201], v6 offset:55360
    ds_read_b64_tr_b16 v[202:203], v6 offset:56896
    v_mfma_f32_32x32x16_bf16 v[80:95], v[156:159], a[0:3], 0
    ds_read_b64_tr_b16 v[204:205], v6 offset:6208
    ds_read_b64_tr_b16 v[206:207], v6 offset:7744
    buffer_load_dwordx4 v24, s[20:23], s66 offen offset:1024 lds
    v_mfma_f32_32x32x16_bf16 v[96:111], v[160:163], a[0:3], 0
    ds_read_b64_tr_b16 v[208:209], v6 offset:55424
    ds_read_b64_tr_b16 v[210:211], v6 offset:56960
    v_mfma_f32_32x32x16_bf16 v[112:127], v[164:167], a[0:3], 0
    ds_read_b64_tr_b16 v[212:213], v6 offset:6272
    ds_read_b64_tr_b16 v[214:215], v6 offset:7808
    s_waitcnt vmcnt(10)
    s_waitcnt lgkmcnt(12)
    v_mfma_f32_32x32x16_bf16 v[32:47], v[168:171], a[4:7], v[32:47]
    ds_read_b64_tr_b16 v[144:145], v6 offset:58368
    ds_read_b64_tr_b16 v[146:147], v6 offset:59904
    buffer_load_dwordx4 a[40:43], v2, s[40:43], s90 offen offset:2048 sc1
    v_mfma_f32_32x32x16_bf16 v[48:63], v[172:175], a[4:7], v[48:63]
    ds_read_b64_tr_b16 v[148:149], v6 offset:9216
    ds_read_b64_tr_b16 v[150:151], v6 offset:10752
    buffer_load_dwordx4 v25, s[20:23], s66 offen offset:2048 lds
    s_add_u32 s65, s65, s84
    s_add_u32 s66, s66, s85
    s_mov_b32 m0, s65
    v_mfma_f32_32x32x16_bf16 v[64:79], v[176:179], a[4:7], v[64:79]
    ds_read_b64_tr_b16 v[152:153], v6 offset:58432
    ds_read_b64_tr_b16 v[154:155], v6 offset:59968
    v_mfma_f32_32x32x16_bf16 v[80:95], v[180:183], a[4:7], v[80:95]
    ds_read_b64_tr_b16 v[156:157], v6 offset:9280
    ds_read_b64_tr_b16 v[158:159], v6 offset:10816
    v_mfma_f32_32x32x16_bf16 v[96:111], v[184:187], a[4:7], v[96:111]
    ds_read_b64_tr_b16 v[160:161], v6 offset:58496
    ds_read_b64_tr_b16 v[162:163], v6 offset:60032
    buffer_load_dwordx4 v4, s[20:23], s66 offen lds
    v_mfma_f32_32x32x16_bf16 v[112:127], v[188:191], a[4:7], v[112:127]
    ds_read_b64_tr_b16 v[164:165], v6 offset:9344
    ds_read_b64_tr_b16 v[166:167], v6 offset:10880
    s_waitcnt vmcnt(12)
    s_waitcnt lgkmcnt(12)
    v_mfma_f32_32x32x16_bf16 v[32:47], v[192:195], a[8:11], v[32:47]
    ds_read_b64_tr_b16 v[168:169], v6 offset:61440
    ds_read_b64_tr_b16 v[170:171], v6 offset:62976
    buffer_load_dwordx4 a[44:47], v2, s[40:43], s90 offen offset:3072 sc1
    v_mfma_f32_32x32x16_bf16 v[48:63], v[196:199], a[8:11], v[48:63]
    ds_read_b64_tr_b16 v[172:173], v6 offset:12288
    ds_read_b64_tr_b16 v[174:175], v6 offset:13824
    v_mfma_f32_32x32x16_bf16 v[64:79], v[200:203], a[8:11], v[64:79]
    ds_read_b64_tr_b16 v[176:177], v6 offset:61504
    ds_read_b64_tr_b16 v[178:179], v6 offset:63040
    buffer_load_dwordx4 v24, s[20:23], s66 offen offset:1024 lds
    v_mfma_f32_32x32x16_bf16 v[80:95], v[204:207], a[8:11], v[80:95]
    ds_read_b64_tr_b16 v[180:181], v6 offset:12352
    ds_read_b64_tr_b16 v[182:183], v6 offset:13888
    v_mfma_f32_32x32x16_bf16 v[96:111], v[208:211], a[8:11], v[96:111]
    ds_read_b64_tr_b16 v[184:185], v6 offset:61568
    ds_read_b64_tr_b16 v[186:187], v6 offset:63104
    v_mfma_f32_32x32x16_bf16 v[112:127], v[212:215], a[8:11], v[112:127]
    ds_read_b64_tr_b16 v[188:189], v6 offset:12416
    ds_read_b64_tr_b16 v[190:191], v6 offset:13952
    s_waitcnt vmcnt(13)
    s_waitcnt lgkmcnt(12)
    v_mfma_f32_32x32x16_bf16 v[32:47], v[144:147], a[12:15], v[32:47]
    ds_read_b64_tr_b16 v[192:193], v6 offset:64512
    ds_read_b64_tr_b16 v[194:195], v7 offset:512
    s_add_u32 s90, s89, 12288
    buffer_load_dwordx4 a[48:51], v2, s[40:43], s90 offen sc1
    buffer_load_dwordx4 v25, s[20:23], s66 offen offset:2048 lds
    s_add_u32 s65, s65, s84
    s_add_u32 s66, s66, s85
    s_mov_b32 m0, s65
    v_mfma_f32_32x32x16_bf16 v[48:63], v[148:151], a[12:15], v[48:63]
    ds_read_b64_tr_b16 v[196:197], v6 offset:15360
    ds_read_b64_tr_b16 v[198:199], v6 offset:16896
    v_mfma_f32_32x32x16_bf16 v[64:79], v[152:155], a[12:15], v[64:79]
    ds_read_b64_tr_b16 v[200:201], v6 offset:64576
    ds_read_b64_tr_b16 v[202:203], v7 offset:576
    v_mfma_f32_32x32x16_bf16 v[80:95], v[156:159], a[12:15], v[80:95]
    ds_read_b64_tr_b16 v[204:205], v6 offset:15424
    ds_read_b64_tr_b16 v[206:207], v6 offset:16960
    buffer_load_dwordx4 v4, s[20:23], s66 offen lds
    v_mfma_f32_32x32x16_bf16 v[96:111], v[160:163], a[12:15], v[96:111]
    ds_read_b64_tr_b16 v[208:209], v6 offset:64640
    ds_read_b64_tr_b16 v[210:211], v7 offset:640
    v_mfma_f32_32x32x16_bf16 v[112:127], v[164:167], a[12:15], v[112:127]
    ds_read_b64_tr_b16 v[212:213], v6 offset:15488
    ds_read_b64_tr_b16 v[214:215], v6 offset:17024
    s_waitcnt vmcnt(15)
    s_waitcnt lgkmcnt(12)
    v_mfma_f32_32x32x16_bf16 v[32:47], v[168:171], a[16:19], v[32:47]
    ds_read_b64_tr_b16 v[144:145], v7 offset:2048
    ds_read_b64_tr_b16 v[146:147], v7 offset:3584
    buffer_load_dwordx4 a[52:55], v2, s[40:43], s90 offen offset:1024 sc1
    v_mfma_f32_32x32x16_bf16 v[48:63], v[172:175], a[16:19], v[48:63]
    ds_read_b64_tr_b16 v[148:149], v6 offset:18432
    ds_read_b64_tr_b16 v[150:151], v6 offset:19968
    buffer_load_dwordx4 v24, s[20:23], s66 offen offset:1024 lds
    v_mfma_f32_32x32x16_bf16 v[64:79], v[176:179], a[16:19], v[64:79]
    ds_read_b64_tr_b16 v[152:153], v7 offset:2112
    ds_read_b64_tr_b16 v[154:155], v7 offset:3648
    v_mfma_f32_32x32x16_bf16 v[80:95], v[180:183], a[16:19], v[80:95]
    ds_read_b64_tr_b16 v[156:157], v6 offset:18496
    ds_read_b64_tr_b16 v[158:159], v6 offset:20032
    v_mfma_f32_32x32x16_bf16 v[96:111], v[184:187], a[16:19], v[96:111]
    ds_read_b64_tr_b16 v[160:161], v7 offset:2176
    ds_read_b64_tr_b16 v[162:163], v7 offset:3712
    buffer_load_dwordx4 v25, s[20:23], s66 offen offset:2048 lds
    v_mfma_f32_32x32x16_bf16 v[112:127], v[188:191], a[16:19], v[112:127]
    ds_read_b64_tr_b16 v[164:165], v6 offset:18560
    ds_read_b64_tr_b16 v[166:167], v6 offset:20096
    s_waitcnt vmcnt(17)
    s_waitcnt lgkmcnt(12)
    v_mfma_f32_32x32x16_bf16 v[32:47], v[192:195], a[20:23], v[32:47]
    ds_read_b64_tr_b16 v[168:169], v7 offset:5120
    ds_read_b64_tr_b16 v[170:171], v7 offset:6656
    buffer_load_dwordx4 a[56:59], v2, s[40:43], s90 offen offset:2048 sc1
    v_mfma_f32_32x32x16_bf16 v[48:63], v[196:199], a[20:23], v[48:63]
    ds_read_b64_tr_b16 v[172:173], v6 offset:21504
    ds_read_b64_tr_b16 v[174:175], v6 offset:23040
    v_mfma_f32_32x32x16_bf16 v[64:79], v[200:203], a[20:23], v[64:79]
    ds_read_b64_tr_b16 v[176:177], v7 offset:5184
    ds_read_b64_tr_b16 v[178:179], v7 offset:6720
    s_mul_i32 s56, s64, 3
    s_min_u32 s56, s56, 7
    s_mul_i32 s57, s82, 2
    s_add_u32 s56, s56, s57
    s_mul_i32 s84, s83, 3072
    s_mul_i32 s85, s83, 44032
    s_mul_i32 s65, s56, 3072
    s_add_u32 s65, s65, 129024
    s_mul_i32 s66, s56, 44032
    s_add_u32 s66, s66, s88
    s_add_u32 s66, s66, 704512
    s_mov_b32 m0, s65
    s_nop 0
    buffer_load_dwordx4 v4, s[24:27], s66 offen lds
    v_mfma_f32_32x32x16_bf16 v[80:95], v[204:207], a[20:23], v[80:95]
    ds_read_b64_tr_b16 v[180:181], v6 offset:21568
    ds_read_b64_tr_b16 v[182:183], v6 offset:23104
    v_mfma_f32_32x32x16_bf16 v[96:111], v[208:211], a[20:23], v[96:111]
    ds_read_b64_tr_b16 v[184:185], v7 offset:5248
    ds_read_b64_tr_b16 v[186:187], v7 offset:6784
    v_mfma_f32_32x32x16_bf16 v[112:127], v[212:215], a[20:23], v[112:127]
    ds_read_b64_tr_b16 v[188:189], v6 offset:21632
    ds_read_b64_tr_b16 v[190:191], v6 offset:23168
    s_waitcnt vmcnt(18)
    s_waitcnt lgkmcnt(12)
    v_mfma_f32_32x32x16_bf16 v[32:47], v[144:147], a[24:27], v[32:47]
    s_barrier
    ds_read_b64_tr_b16 v[192:193], v7 offset:8192
    ds_read_b64_tr_b16 v[194:195], v7 offset:9728
    buffer_load_dwordx4 a[60:63], v2, s[40:43], s90 offen offset:3072 sc1
    buffer_load_dwordx4 v24, s[24:27], s66 offen offset:1024 lds
    v_mfma_f32_32x32x16_bf16 v[48:63], v[148:151], a[24:27], v[48:63]
    ds_read_b64_tr_b16 v[196:197], v6 offset:24576
    ds_read_b64_tr_b16 v[198:199], v6 offset:26112
    v_mfma_f32_32x32x16_bf16 v[64:79], v[152:155], a[24:27], v[64:79]
    ds_read_b64_tr_b16 v[200:201], v7 offset:8256
    ds_read_b64_tr_b16 v[202:203], v7 offset:9792
    v_mfma_f32_32x32x16_bf16 v[80:95], v[156:159], a[24:27], v[80:95]
    ds_read_b64_tr_b16 v[204:205], v6 offset:24640
    ds_read_b64_tr_b16 v[206:207], v6 offset:26176
    buffer_load_dwordx4 v25, s[24:27], s66 offen offset:2048 lds
    s_add_u32 s65, s65, s84
    s_add_u32 s66, s66, s85
    s_mov_b32 m0, s65
    v_mfma_f32_32x32x16_bf16 v[96:111], v[160:163], a[24:27], v[96:111]
    ds_read_b64_tr_b16 v[208:209], v7 offset:8320
    ds_read_b64_tr_b16 v[210:211], v7 offset:9856
    v_mfma_f32_32x32x16_bf16 v[112:127], v[164:167], a[24:27], v[112:127]
    ds_read_b64_tr_b16 v[212:213], v6 offset:24704
    ds_read_b64_tr_b16 v[214:215], v6 offset:26240
    s_waitcnt vmcnt(20)
    s_waitcnt lgkmcnt(12)
    v_mfma_f32_32x32x16_bf16 v[32:47], v[168:171], a[28:31], v[32:47]
    ds_read_b64_tr_b16 v[144:145], v7 offset:11264
    ds_read_b64_tr_b16 v[146:147], v7 offset:12800
    s_add_u32 s90, s89, 16384
    buffer_load_dwordx4 a[64:67], v2, s[40:43], s90 offen sc1
    v_mfma_f32_32x32x16_bf16 v[48:63], v[172:175], a[28:31], v[48:63]
    ds_read_b64_tr_b16 v[148:149], v6 offset:27648
    ds_read_b64_tr_b16 v[150:151], v6 offset:29184
    buffer_load_dwordx4 v4, s[24:27], s66 offen lds
    v_mfma_f32_32x32x16_bf16 v[64:79], v[176:179], a[28:31], v[64:79]
    ds_read_b64_tr_b16 v[152:153], v7 offset:11328
    ds_read_b64_tr_b16 v[154:155], v7 offset:12864
    v_mfma_f32_32x32x16_bf16 v[80:95], v[180:183], a[28:31], v[80:95]
    ds_read_b64_tr_b16 v[156:157], v6 offset:27712
    ds_read_b64_tr_b16 v[158:159], v6 offset:29248
    v_mfma_f32_32x32x16_bf16 v[96:111], v[184:187], a[28:31], v[96:111]
    ds_read_b64_tr_b16 v[160:161], v7 offset:11392
    ds_read_b64_tr_b16 v[162:163], v7 offset:12928
    buffer_load_dwordx4 v24, s[24:27], s66 offen offset:1024 lds
    v_mfma_f32_32x32x16_bf16 v[112:127], v[188:191], a[28:31], v[112:127]
    ds_read_b64_tr_b16 v[164:165], v6 offset:27776
    ds_read_b64_tr_b16 v[166:167], v6 offset:29312
    s_waitcnt vmcnt(22)
    s_waitcnt lgkmcnt(12)
    v_mfma_f32_32x32x16_bf16 v[32:47], v[192:195], a[32:35], v[32:47]
    ds_read_b64_tr_b16 v[168:169], v7 offset:14336
    ds_read_b64_tr_b16 v[170:171], v7 offset:15872
    buffer_load_dwordx4 a[68:71], v2, s[40:43], s90 offen offset:1024 sc1
    v_mfma_f32_32x32x16_bf16 v[48:63], v[196:199], a[32:35], v[48:63]
    ds_read_b64_tr_b16 v[172:173], v6 offset:30720
    ds_read_b64_tr_b16 v[174:175], v6 offset:32256
    v_mfma_f32_32x32x16_bf16 v[64:79], v[200:203], a[32:35], v[64:79]
    ds_read_b64_tr_b16 v[176:177], v7 offset:14400
    ds_read_b64_tr_b16 v[178:179], v7 offset:15936
    buffer_load_dwordx4 v25, s[24:27], s66 offen offset:2048 lds
    s_add_u32 s65, s65, s84
    s_add_u32 s66, s66, s85
    s_mov_b32 m0, s65
    v_mfma_f32_32x32x16_bf16 v[80:95], v[204:207], a[32:35], v[80:95]
    ds_read_b64_tr_b16 v[180:181], v6 offset:30784
    ds_read_b64_tr_b16 v[182:183], v6 offset:32320
    v_mfma_f32_32x32x16_bf16 v[96:111], v[208:211], a[32:35], v[96:111]
    ds_read_b64_tr_b16 v[184:185], v7 offset:14464
    ds_read_b64_tr_b16 v[186:187], v7 offset:16000
    v_mfma_f32_32x32x16_bf16 v[112:127], v[212:215], a[32:35], v[112:127]
    ds_read_b64_tr_b16 v[188:189], v6 offset:30848
    ds_read_b64_tr_b16 v[190:191], v6 offset:32384
    s_waitcnt vmcnt(23)
    s_waitcnt lgkmcnt(12)
    v_mfma_f32_32x32x16_bf16 v[32:47], v[144:147], a[36:39], v[32:47]
    ds_read_b64_tr_b16 v[192:193], v7 offset:17408
    ds_read_b64_tr_b16 v[194:195], v7 offset:18944
    buffer_load_dwordx4 a[72:75], v2, s[40:43], s90 offen offset:2048 sc1
    buffer_load_dwordx4 v4, s[24:27], s66 offen lds
    v_mfma_f32_32x32x16_bf16 v[48:63], v[148:151], a[36:39], v[48:63]
    ds_read_b64_tr_b16 v[196:197], v6 offset:33792
    ds_read_b64_tr_b16 v[198:199], v6 offset:35328
    v_mfma_f32_32x32x16_bf16 v[64:79], v[152:155], a[36:39], v[64:79]
    ds_read_b64_tr_b16 v[200:201], v7 offset:17472
    ds_read_b64_tr_b16 v[202:203], v7 offset:19008
    v_mfma_f32_32x32x16_bf16 v[80:95], v[156:159], a[36:39], v[80:95]
    ds_read_b64_tr_b16 v[204:205], v6 offset:33856
    ds_read_b64_tr_b16 v[206:207], v6 offset:35392
    buffer_load_dwordx4 v24, s[24:27], s66 offen offset:1024 lds
    v_mfma_f32_32x32x16_bf16 v[96:111], v[160:163], a[36:39], v[96:111]
    ds_read_b64_tr_b16 v[208:209], v7 offset:17536
    ds_read_b64_tr_b16 v[210:211], v7 offset:19072
    v_mfma_f32_32x32x16_bf16 v[112:127], v[164:167], a[36:39], v[112:127]
    ds_read_b64_tr_b16 v[212:213], v6 offset:33920
    ds_read_b64_tr_b16 v[214:215], v6 offset:35456
    s_waitcnt vmcnt(23)
    s_waitcnt lgkmcnt(12)
    v_mfma_f32_32x32x16_bf16 v[32:47], v[168:171], a[40:43], v[32:47]
    ds_read_b64_tr_b16 v[144:145], v7 offset:20480
    ds_read_b64_tr_b16 v[146:147], v7 offset:22016
    buffer_load_dwordx4 a[76:79], v2, s[40:43], s90 offen offset:3072 sc1
    v_mfma_f32_32x32x16_bf16 v[48:63], v[172:175], a[40:43], v[48:63]
    ds_read_b64_tr_b16 v[148:149], v6 offset:36864
    ds_read_b64_tr_b16 v[150:151], v6 offset:38400
    buffer_load_dwordx4 v25, s[24:27], s66 offen offset:2048 lds
    v_mfma_f32_32x32x16_bf16 v[64:79], v[176:179], a[40:43], v[64:79]
    ds_read_b64_tr_b16 v[152:153], v7 offset:20544
    ds_read_b64_tr_b16 v[154:155], v7 offset:22080
    v_mfma_f32_32x32x16_bf16 v[80:95], v[180:183], a[40:43], v[80:95]
    ds_read_b64_tr_b16 v[156:157], v6 offset:36928
    ds_read_b64_tr_b16 v[158:159], v6 offset:38464
    v_mfma_f32_32x32x16_bf16 v[96:111], v[184:187], a[40:43], v[96:111]
    ds_read_b64_tr_b16 v[160:161], v7 offset:20608
    ds_read_b64_tr_b16 v[162:163], v7 offset:22144
    v_mfma_f32_32x32x16_bf16 v[112:127], v[188:191], a[40:43], v[112:127]
    ds_read_b64_tr_b16 v[164:165], v6 offset:36992
    ds_read_b64_tr_b16 v[166:167], v6 offset:38528
    s_waitcnt vmcnt(22)
    s_waitcnt lgkmcnt(12)
    v_mfma_f32_32x32x16_bf16 v[32:47], v[192:195], a[44:47], v[32:47]
    ds_read_b64_tr_b16 v[168:169], v7 offset:23552
    ds_read_b64_tr_b16 v[170:171], v7 offset:25088
    s_add_u32 s90, s89, 20480
    buffer_load_dwordx4 a[80:83], v2, s[40:43], s90 offen sc1
    v_mfma_f32_32x32x16_bf16 v[48:63], v[196:199], a[44:47], v[48:63]
    ds_read_b64_tr_b16 v[172:173], v6 offset:39936
    ds_read_b64_tr_b16 v[174:175], v6 offset:41472
    s_mul_i32 s56, s64, 2
    s_min_u32 s56, s56, 4
    s_mul_i32 s57, s82, 1
    s_add_u32 s56, s56, s57
    s_mul_i32 s84, s83, 3072
    s_mul_i32 s85, s83, 44032
    s_mul_i32 s65, s56, 3072
    s_add_u32 s65, s65, 49152
    s_mul_i32 s66, s56, 44032
    s_add_u32 s66, s66, s88
    s_add_u32 s66, s66, 1144832
    s_mov_b32 m0, s65
    s_nop 0
    buffer_load_dwordx4 v4, s[20:23], s66 offen lds
    v_mfma_f32_32x32x16_bf16 v[64:79], v[200:203], a[44:47], v[64:79]
    ds_read_b64_tr_b16 v[176:177], v7 offset:23616
    ds_read_b64_tr_b16 v[178:179], v7 offset:25152
    v_mfma_f32_32x32x16_bf16 v[80:95], v[204:207], a[44:47], v[80:95]
    ds_read_b64_tr_b16 v[180:181], v6 offset:40000
    ds_read_b64_tr_b16 v[182:183], v6 offset:41536
    v_mfma_f32_32x32x16_bf16 v[96:111], v[208:211], a[44:47], v[96:111]
    ds_read_b64_tr_b16 v[184:185], v7 offset:23680
    ds_read_b64_tr_b16 v[186:187], v7 offset:25216
    v_mfma_f32_32x32x16_bf16 v[112:127], v[212:215], a[44:47], v[112:127]
    ds_read_b64_tr_b16 v[188:189], v6 offset:40064
    ds_read_b64_tr_b16 v[190:191], v6 offset:41600
    buffer_load_dwordx4 v24, s[20:23], s66 offen offset:1024 lds
    s_waitcnt vmcnt(23)
    s_waitcnt lgkmcnt(12)
    v_mfma_f32_32x32x16_bf16 v[32:47], v[144:147], a[48:51], v[32:47]
    ds_read_b64_tr_b16 v[192:193], v7 offset:26624
    ds_read_b64_tr_b16 v[194:195], v7 offset:28160
    buffer_load_dwordx4 a[84:87], v2, s[40:43], s90 offen offset:1024 sc1
    v_mfma_f32_32x32x16_bf16 v[48:63], v[148:151], a[48:51], v[48:63]
    ds_read_b64_tr_b16 v[196:197], v6 offset:43008
    ds_read_b64_tr_b16 v[198:199], v6 offset:44544
    v_mfma_f32_32x32x16_bf16 v[64:79], v[152:155], a[48:51], v[64:79]
    ds_read_b64_tr_b16 v[200:201], v7 offset:26688
    ds_read_b64_tr_b16 v[202:203], v7 offset:28224
    v_mfma_f32_32x32x16_bf16 v[80:95], v[156:159], a[48:51], v[80:95]
    ds_read_b64_tr_b16 v[204:205], v6 offset:43072
    ds_read_b64_tr_b16 v[206:207], v6 offset:44608
    buffer_load_dwordx4 v25, s[20:23], s66 offen offset:2048 lds
    s_add_u32 s65, s65, s84
    s_add_u32 s66, s66, s85
    s_mov_b32 m0, s65
    v_mfma_f32_32x32x16_bf16 v[96:111], v[160:163], a[48:51], v[96:111]
    ds_read_b64_tr_b16 v[208:209], v7 offset:26752
    ds_read_b64_tr_b16 v[210:211], v7 offset:28288
    v_mfma_f32_32x32x16_bf16 v[112:127], v[164:167], a[48:51], v[112:127]
    ds_read_b64_tr_b16 v[212:213], v6 offset:43136
    ds_read_b64_tr_b16 v[214:215], v6 offset:44672
    s_waitcnt vmcnt(22)
    s_waitcnt lgkmcnt(12)
    v_mfma_f32_32x32x16_bf16 v[32:47], v[168:171], a[52:55], v[32:47]
    ds_read_b64_tr_b16 v[144:145], v7 offset:29696
    ds_read_b64_tr_b16 v[146:147], v7 offset:31232
    buffer_load_dwordx4 a[88:91], v2, s[40:43], s90 offen offset:2048 sc1
    v_mfma_f32_32x32x16_bf16 v[48:63], v[172:175], a[52:55], v[48:63]
    ds_read_b64_tr_b16 v[148:149], v6 offset:46080
    ds_read_b64_tr_b16 v[150:151], v6 offset:47616
    buffer_load_dwordx4 v4, s[20:23], s66 offen lds
    v_mfma_f32_32x32x16_bf16 v[64:79], v[176:179], a[52:55], v[64:79]
    ds_read_b64_tr_b16 v[152:153], v7 offset:29760
    ds_read_b64_tr_b16 v[154:155], v7 offset:31296
    v_mfma_f32_32x32x16_bf16 v[80:95], v[180:183], a[52:55], v[80:95]
    ds_read_b64_tr_b16 v[156:157], v6 offset:46144
    ds_read_b64_tr_b16 v[158:159], v6 offset:47680
    v_mfma_f32_32x32x16_bf16 v[96:111], v[184:187], a[52:55], v[96:111]
    ds_read_b64_tr_b16 v[160:161], v7 offset:29824
    ds_read_b64_tr_b16 v[162:163], v7 offset:31360
    v_mfma_f32_32x32x16_bf16 v[112:127], v[188:191], a[52:55], v[112:127]
    ds_read_b64_tr_b16 v[164:165], v6 offset:46208
    ds_read_b64_tr_b16 v[166:167], v6 offset:47744
    buffer_load_dwordx4 v24, s[20:23], s66 offen offset:1024 lds
    s_waitcnt vmcnt(22)
    s_waitcnt lgkmcnt(12)
    v_mfma_f32_32x32x16_bf16 v[32:47], v[192:195], a[56:59], v[32:47]
    s_waitcnt vmcnt(8)
    s_barrier
    ds_read_b64_tr_b16 v[168:169], v7 offset:32768
    ds_read_b64_tr_b16 v[170:171], v7 offset:34304
    buffer_load_dwordx4 a[92:95], v2, s[40:43], s90 offen offset:3072 sc1
    v_mfma_f32_32x32x16_bf16 v[48:63], v[196:199], a[56:59], v[48:63]
    ds_read_b64_tr_b16 v[172:173], v7 offset:63488
    ds_read_b64_tr_b16 v[174:175], v7 offset:65024
    v_mfma_f32_32x32x16_bf16 v[64:79], v[200:203], a[56:59], v[64:79]
    ds_read_b64_tr_b16 v[176:177], v7 offset:32832
    ds_read_b64_tr_b16 v[178:179], v7 offset:34368
    v_mfma_f32_32x32x16_bf16 v[80:95], v[204:207], a[56:59], v[80:95]
    ds_read_b64_tr_b16 v[180:181], v7 offset:63552
    ds_read_b64_tr_b16 v[182:183], v7 offset:65088
    buffer_load_dwordx4 v25, s[20:23], s66 offen offset:2048 lds
    v_mfma_f32_32x32x16_bf16 v[96:111], v[208:211], a[56:59], v[96:111]
    ds_read_b64_tr_b16 v[184:185], v7 offset:32896
    ds_read_b64_tr_b16 v[186:187], v7 offset:34432
    v_mfma_f32_32x32x16_bf16 v[112:127], v[212:215], a[56:59], v[112:127]
    ds_read_b64_tr_b16 v[188:189], v7 offset:63616
    ds_read_b64_tr_b16 v[190:191], v7 offset:65152
    s_waitcnt lgkmcnt(12)
    v_mfma_f32_32x32x16_bf16 v[32:47], v[144:147], a[60:63], v[32:47]
    ds_read_b64_tr_b16 v[192:193], v7 offset:35840
    ds_read_b64_tr_b16 v[194:195], v7 offset:37376
    s_add_u32 s90, s89, 24576
    buffer_load_dwordx4 a[96:99], v2, s[40:43], s90 offen sc1
    v_mfma_f32_32x32x16_bf16 v[48:63], v[148:151], a[60:63], v[48:63]
    ds_read_b64_tr_b16 v[196:197], v8 offset:1024
    ds_read_b64_tr_b16 v[198:199], v8 offset:2560
    v_mfma_f32_32x32x16_bf16 v[64:79], v[152:155], a[60:63], v[64:79]
    ds_read_b64_tr_b16 v[200:201], v7 offset:35904
    ds_read_b64_tr_b16 v[202:203], v7 offset:37440
    s_mul_i32 s56, s64, 2
    s_min_u32 s56, s56, 4
    s_mul_i32 s57, s82, 1
    s_add_u32 s56, s56, s57
    s_mul_i32 s84, s83, 3072
    s_mul_i32 s85, s83, 44032
    s_mul_i32 s65, s56, 3072
    s_mul_i32 s66, s56, 44032
    s_add_u32 s66, s66, s88
    s_add_u32 s66, s66, 1144832
    s_mov_b32 m0, s65
    s_nop 0
    buffer_load_dwordx4 v4, s[24:27], s66 offen lds
    v_mfma_f32_32x32x16_bf16 v[80:95], v[156:159], a[60:63], v[80:95]
    ds_read_b64_tr_b16 v[204:205], v8 offset:1088
    ds_read_b64_tr_b16 v[206:207], v8 offset:2624
    v_mfma_f32_32x32x16_bf16 v[96:111], v[160:163], a[60:63], v[96:111]
    ds_read_b64_tr_b16 v[208:209], v7 offset:35968
    ds_read_b64_tr_b16 v[210:211], v7 offset:37504
    v_mfma_f32_32x32x16_bf16 v[112:127], v[164:167], a[60:63], v[112:127]
    ds_read_b64_tr_b16 v[212:213], v8 offset:1152
    ds_read_b64_tr_b16 v[214:215], v8 offset:2688
    s_waitcnt lgkmcnt(12)
    v_mfma_f32_32x32x16_bf16 v[32:47], v[168:171], a[64:67], v[32:47]
    s_barrier
    ds_read_b64_tr_b16 v[144:145], v7 offset:38912
    ds_read_b64_tr_b16 v[146:147], v7 offset:40448
    buffer_load_dwordx4 a[100:103], v2, s[40:43], s90 offen offset:1024 sc1
    buffer_load_dwordx4 v24, s[24:27], s66 offen offset:1024 lds
    v_mfma_f32_32x32x16_bf16 v[48:63], v[172:175], a[64:67], v[48:63]
    ds_read_b64_tr_b16 v[148:149], v8 offset:4096
    ds_read_b64_tr_b16 v[150:151], v8 offset:5632
    v_mfma_f32_32x32x16_bf16 v[64:79], v[176:179], a[64:67], v[64:79]
    ds_read_b64_tr_b16 v[152:153], v7 offset:38976
    ds_read_b64_tr_b16 v[154:155], v7 offset:40512
    v_mfma_f32_32x32x16_bf16 v[80:95], v[180:183], a[64:67], v[80:95]
    ds_read_b64_tr_b16 v[156:157], v8 offset:4160
    ds_read_b64_tr_b16 v[158:159], v8 offset:5696
    v_mfma_f32_32x32x16_bf16 v[96:111], v[184:187], a[64:67], v[96:111]
    ds_read_b64_tr_b16 v[160:161], v7 offset:39040
    ds_read_b64_tr_b16 v[162:163], v7 offset:40576
    buffer_load_dwordx4 v25, s[24:27], s66 offen offset:2048 lds
    s_add_u32 s65, s65, s84
    s_add_u32 s66, s66, s85
    s_mov_b32 m0, s65
    v_mfma_f32_32x32x16_bf16 v[112:127], v[188:191], a[64:67], v[112:127]
    ds_read_b64_tr_b16 v[164:165], v8 offset:4224
    ds_read_b64_tr_b16 v[166:167], v8 offset:5760
    s_waitcnt lgkmcnt(12)
    v_mfma_f32_32x32x16_bf16 v[32:47], v[192:195], a[68:71], v[32:47]
    ds_read_b64_tr_b16 v[168:169], v7 offset:41984
    ds_read_b64_tr_b16 v[170:171], v7 offset:43520
    buffer_load_dwordx4 a[104:107], v2, s[40:43], s90 offen offset:2048 sc1
    v_mfma_f32_32x32x16_bf16 v[48:63], v[196:199], a[68:71], v[48:63]
    ds_read_b64_tr_b16 v[172:173], v8 offset:7168
    ds_read_b64_tr_b16 v[174:175], v8 offset:8704
    v_mfma_f32_32x32x16_bf16 v[64:79], v[200:203], a[68:71], v[64:79]
    ds_read_b64_tr_b16 v[176:177], v7 offset:42048
    ds_read_b64_tr_b16 v[178:179], v7 offset:43584
    buffer_load_dwordx4 v4, s[24:27], s66 offen lds
    v_mfma_f32_32x32x16_bf16 v[80:95], v[204:207], a[68:71], v[80:95]
    ds_read_b64_tr_b16 v[180:181], v8 offset:7232
    ds_read_b64_tr_b16 v[182:183], v8 offset:8768
    v_mfma_f32_32x32x16_bf16 v[96:111], v[208:211], a[68:71], v[96:111]
    ds_read_b64_tr_b16 v[184:185], v7 offset:42112
    ds_read_b64_tr_b16 v[186:187], v7 offset:43648
    v_mfma_f32_32x32x16_bf16 v[112:127], v[212:215], a[68:71], v[112:127]
    ds_read_b64_tr_b16 v[188:189], v8 offset:7296
    ds_read_b64_tr_b16 v[190:191], v8 offset:8832
    s_waitcnt lgkmcnt(12)
    v_mfma_f32_32x32x16_bf16 v[32:47], v[144:147], a[72:75], v[32:47]
    ds_read_b64_tr_b16 v[192:193], v7 offset:45056
    ds_read_b64_tr_b16 v[194:195], v7 offset:46592
    buffer_load_dwordx4 a[108:111], v2, s[40:43], s90 offen offset:3072 sc1
    buffer_load_dwordx4 v24, s[24:27], s66 offen offset:1024 lds
    v_mfma_f32_32x32x16_bf16 v[48:63], v[148:151], a[72:75], v[48:63]
    ds_read_b64_tr_b16 v[196:197], v8 offset:10240
    ds_read_b64_tr_b16 v[198:199], v8 offset:11776
    v_mfma_f32_32x32x16_bf16 v[64:79], v[152:155], a[72:75], v[64:79]
    ds_read_b64_tr_b16 v[200:201], v7 offset:45120
    ds_read_b64_tr_b16 v[202:203], v7 offset:46656
    v_mfma_f32_32x32x16_bf16 v[80:95], v[156:159], a[72:75], v[80:95]
    ds_read_b64_tr_b16 v[204:205], v8 offset:10304
    ds_read_b64_tr_b16 v[206:207], v8 offset:11840
    v_mfma_f32_32x32x16_bf16 v[96:111], v[160:163], a[72:75], v[96:111]
    ds_read_b64_tr_b16 v[208:209], v7 offset:45184
    ds_read_b64_tr_b16 v[210:211], v7 offset:46720
    buffer_load_dwordx4 v25, s[24:27], s66 offen offset:2048 lds
    v_mfma_f32_32x32x16_bf16 v[112:127], v[164:167], a[72:75], v[112:127]
    ds_read_b64_tr_b16 v[212:213], v8 offset:10368
    ds_read_b64_tr_b16 v[214:215], v8 offset:11904
    s_waitcnt lgkmcnt(12)
    v_mfma_f32_32x32x16_bf16 v[32:47], v[168:171], a[76:79], v[32:47]
    ds_read_b64_tr_b16 v[144:145], v7 offset:48128
    ds_read_b64_tr_b16 v[146:147], v7 offset:49664
    s_add_u32 s90, s89, 28672
    buffer_load_dwordx4 a[112:115], v2, s[40:43], s90 offen sc1
    v_mfma_f32_32x32x16_bf16 v[48:63], v[172:175], a[76:79], v[48:63]
    ds_read_b64_tr_b16 v[148:149], v8 offset:13312
    ds_read_b64_tr_b16 v[150:151], v8 offset:14848
    v_mfma_f32_32x32x16_bf16 v[64:79], v[176:179], a[76:79], v[64:79]
    ds_read_b64_tr_b16 v[152:153], v7 offset:48192
    ds_read_b64_tr_b16 v[154:155], v7 offset:49728
    v_mfma_f32_32x32x16_bf16 v[80:95], v[180:183], a[76:79], v[80:95]
    ds_read_b64_tr_b16 v[156:157], v8 offset:13376
    ds_read_b64_tr_b16 v[158:159], v8 offset:14912
    v_mfma_f32_32x32x16_bf16 v[96:111], v[184:187], a[76:79], v[96:111]
    ds_read_b64_tr_b16 v[160:161], v7 offset:48256
    ds_read_b64_tr_b16 v[162:163], v7 offset:49792
    v_mfma_f32_32x32x16_bf16 v[112:127], v[188:191], a[76:79], v[112:127]
    ds_read_b64_tr_b16 v[164:165], v8 offset:13440
    ds_read_b64_tr_b16 v[166:167], v8 offset:14976
    s_mul_i32 s56, s64, 2
    s_min_u32 s56, s56, 5
    s_mul_i32 s57, s82, 1
    s_add_u32 s56, s56, s57
    s_lshl_b32 s84, s83, 11
    s_mul_i32 s57, s96, 1
    s_mul_i32 s57, s57, s83
    s_add_u32 s56, s56, s57
    s_mul_i32 s95, s96, 2
    s_mul_i32 s95, s95, s83
    s_lshl_b32 s65, s56, 11
    s_add_u32 s65, s65, 18432
    s_add_u32 s98, s56, 0
    s_lshl_b32 s66, s98, 14
    s_add_u32 s66, s66, s87
    s_mov_b32 m0, s65
    s_nop 0
    buffer_load_dwordx4 v5, s[28:31], s66 offen lds
    s_waitcnt vmcnt(21)
    s_waitcnt lgkmcnt(12)
    v_mfma_f32_32x32x16_bf16 v[32:47], v[192:195], a[80:83], v[32:47]
    ds_read_b64_tr_b16 v[168:169], v7 offset:51200
    ds_read_b64_tr_b16 v[170:171], v7 offset:52736
    buffer_load_dwordx4 a[116:119], v2, s[40:43], s90 offen offset:1024 sc1
    v_mfma_f32_32x32x16_bf16 v[48:63], v[196:199], a[80:83], v[48:63]
    ds_read_b64_tr_b16 v[172:173], v8 offset:16384
    ds_read_b64_tr_b16 v[174:175], v8 offset:17920
    buffer_load_dwordx4 v20, s[28:31], s66 offen offset:1024 lds
    s_sub_u32 s56, s83, s95
    s_add_u32 s98, s98, s56
    s_lshl_b32 s56, s56, 11
    s_add_u32 s65, s65, s56
    v_mfma_f32_32x32x16_bf16 v[64:79], v[200:203], a[80:83], v[64:79]
    ds_read_b64_tr_b16 v[176:177], v7 offset:51264
    ds_read_b64_tr_b16 v[178:179], v7 offset:52800
    v_mfma_f32_32x32x16_bf16 v[80:95], v[204:207], a[80:83], v[80:95]
    ds_read_b64_tr_b16 v[180:181], v8 offset:16448
    ds_read_b64_tr_b16 v[182:183], v8 offset:17984
    v_mfma_f32_32x32x16_bf16 v[96:111], v[208:211], a[80:83], v[96:111]
    ds_read_b64_tr_b16 v[184:185], v7 offset:51328
    ds_read_b64_tr_b16 v[186:187], v7 offset:52864
    s_lshl_b32 s66, s98, 14
    s_add_u32 s66, s66, s87
    s_mov_b32 m0, s65
    s_nop 0
    buffer_load_dwordx4 v5, s[28:31], s66 offen lds
    v_mfma_f32_32x32x16_bf16 v[112:127], v[212:215], a[80:83], v[112:127]
    ds_read_b64_tr_b16 v[188:189], v8 offset:16512
    ds_read_b64_tr_b16 v[190:191], v8 offset:18048
    s_waitcnt vmcnt(21)
    s_waitcnt lgkmcnt(12)
    v_mfma_f32_32x32x16_bf16 v[32:47], v[144:147], a[84:87], v[32:47]
    ds_read_b64_tr_b16 v[192:193], v7 offset:54272
    ds_read_b64_tr_b16 v[194:195], v7 offset:55808
    buffer_load_dwordx4 a[120:123], v2, s[40:43], s90 offen offset:2048 sc1
    buffer_load_dwordx4 v20, s[28:31], s66 offen offset:1024 lds
    v_mfma_f32_32x32x16_bf16 v[48:63], v[148:151], a[84:87], v[48:63]
    ds_read_b64_tr_b16 v[196:197], v8 offset:19456
    ds_read_b64_tr_b16 v[198:199], v8 offset:20992
    v_mfma_f32_32x32x16_bf16 v[64:79], v[152:155], a[84:87], v[64:79]
    ds_read_b64_tr_b16 v[200:201], v7 offset:54336
    ds_read_b64_tr_b16 v[202:203], v7 offset:55872
    v_mfma_f32_32x32x16_bf16 v[80:95], v[156:159], a[84:87], v[80:95]
    ds_read_b64_tr_b16 v[204:205], v8 offset:19520
    ds_read_b64_tr_b16 v[206:207], v8 offset:21056
    s_mul_i32 s56, s64, 2
    s_min_u32 s56, s56, 5
    s_mul_i32 s57, s82, 1
    s_add_u32 s56, s56, s57
    s_lshl_b32 s84, s83, 11
    s_mul_i32 s57, s96, 1
    s_mul_i32 s57, s57, s83
    s_add_u32 s56, s56, s57
    s_mul_i32 s95, s96, 2
    s_mul_i32 s95, s95, s83
    s_lshl_b32 s65, s56, 11
    s_add_u32 s65, s65, 32768
    s_add_u32 s98, s56, 0
    s_lshl_b32 s66, s98, 14
    s_add_u32 s66, s66, s87
    s_add_u32 s66, s66, 704512
    s_mov_b32 m0, s65
    s_nop 0
    buffer_load_dwordx4 v5, s[28:31], s66 offen lds
    v_mfma_f32_32x32x16_bf16 v[96:111], v[160:163], a[84:87], v[96:111]
    ds_read_b64_tr_b16 v[208:209], v7 offset:54400
    ds_read_b64_tr_b16 v[210:211], v7 offset:55936
    v_mfma_f32_32x32x16_bf16 v[112:127], v[164:167], a[84:87], v[112:127]
    ds_read_b64_tr_b16 v[212:213], v8 offset:19584
    ds_read_b64_tr_b16 v[214:215], v8 offset:21120
    buffer_load_dwordx4 v20, s[28:31], s66 offen offset:1024 lds
    s_sub_u32 s56, s83, s95
    s_add_u32 s98, s98, s56
    s_lshl_b32 s56, s56, 11
    s_add_u32 s65, s65, s56
    s_waitcnt vmcnt(23)
    s_waitcnt lgkmcnt(12)
    v_mfma_f32_32x32x16_bf16 v[32:47], v[168:171], a[88:91], v[32:47]
    ds_read_b64_tr_b16 v[144:145], v7 offset:57344
    ds_read_b64_tr_b16 v[146:147], v7 offset:58880
    buffer_load_dwordx4 a[124:127], v2, s[40:43], s90 offen offset:3072 sc1
    v_mfma_f32_32x32x16_bf16 v[48:63], v[172:175], a[88:91], v[48:63]
    ds_read_b64_tr_b16 v[148:149], v8 offset:22528
    ds_read_b64_tr_b16 v[150:151], v8 offset:24064
    v_mfma_f32_32x32x16_bf16 v[64:79], v[176:179], a[88:91], v[64:79]
    ds_read_b64_tr_b16 v[152:153], v7 offset:57408
    ds_read_b64_tr_b16 v[154:155], v7 offset:58944
    s_lshl_b32 s66, s98, 14
    s_add_u32 s66, s66, s87
    s_add_u32 s66, s66, 704512
    s_mov_b32 m0, s65
    s_nop 0
    buffer_load_dwordx4 v5, s[28:31], s66 offen lds
    v_mfma_f32_32x32x16_bf16 v[80:95], v[180:183], a[88:91], v[80:95]
    ds_read_b64_tr_b16 v[156:157], v8 offset:22592
    ds_read_b64_tr_b16 v[158:159], v8 offset:24128
    v_mfma_f32_32x32x16_bf16 v[96:111], v[184:187], a[88:91], v[96:111]
    ds_read_b64_tr_b16 v[160:161], v7 offset:57472
    ds_read_b64_tr_b16 v[162:163], v7 offset:59008
    buffer_load_dwordx4 v20, s[28:31], s66 offen offset:1024 lds
    v_mfma_f32_32x32x16_bf16 v[112:127], v[188:191], a[88:91], v[112:127]
    ds_read_b64_tr_b16 v[164:165], v8 offset:22656
    ds_read_b64_tr_b16 v[166:167], v8 offset:24192
    s_waitcnt vmcnt(23)
    s_waitcnt lgkmcnt(12)
    v_mfma_f32_32x32x16_bf16 v[32:47], v[192:195], a[92:95], v[32:47]
    ds_read_b64_tr_b16 v[168:169], v7 offset:60416
    ds_read_b64_tr_b16 v[170:171], v7 offset:61952
    v_mfma_f32_32x32x16_bf16 v[48:63], v[196:199], a[92:95], v[48:63]
    ds_read_b64_tr_b16 v[172:173], v8 offset:25600
    ds_read_b64_tr_b16 v[174:175], v8 offset:27136
    s_mul_i32 s56, s64, 2
    s_min_u32 s56, s56, 5
    s_mul_i32 s57, s82, 1
    s_add_u32 s56, s56, s57
    s_lshl_b32 s84, s83, 11
    s_mul_i32 s57, s96, 1
    s_mul_i32 s57, s57, s83
    s_add_u32 s56, s56, s57
    s_mul_i32 s95, s96, 2
    s_mul_i32 s95, s95, s83
    s_lshl_b32 s65, s56, 11
    s_add_u32 s65, s65, 67584
    s_add_u32 s98, s56, 7
    s_lshl_b32 s66, s98, 14
    s_add_u32 s66, s66, s87
    s_mov_b32 m0, s65
    s_nop 0
    buffer_load_dwordx4 v5, s[28:31], s66 offen lds
    v_mfma_f32_32x32x16_bf16 v[64:79], v[200:203], a[92:95], v[64:79]
    ds_read_b64_tr_b16 v[176:177], v7 offset:60480
    ds_read_b64_tr_b16 v[178:179], v7 offset:62016
    v_mfma_f32_32x32x16_bf16 v[80:95], v[204:207], a[92:95], v[80:95]
    ds_read_b64_tr_b16 v[180:181], v8 offset:25664
    ds_read_b64_tr_b16 v[182:183], v8 offset:27200
    buffer_load_dwordx4 v20, s[28:31], s66 offen offset:1024 lds
    s_sub_u32 s56, s83, s95
    s_add_u32 s98, s98, s56
    s_lshl_b32 s56, s56, 11
    s_add_u32 s65, s65, s56
    v_mfma_f32_32x32x16_bf16 v[96:111], v[208:211], a[92:95], v[96:111]
    ds_read_b64_tr_b16 v[184:185], v7 offset:60544
    ds_read_b64_tr_b16 v[186:187], v7 offset:62080
    v_mfma_f32_32x32x16_bf16 v[112:127], v[212:215], a[92:95], v[112:127]
    ds_read_b64_tr_b16 v[188:189], v8 offset:25728
    ds_read_b64_tr_b16 v[190:191], v8 offset:27264
    s_waitcnt vmcnt(23)
    s_waitcnt lgkmcnt(12)
    v_mfma_f32_32x32x16_bf16 v[32:47], v[144:147], a[96:99], v[32:47]
    s_waitcnt vmcnt(14)
    s_barrier
    ds_read_b64_tr_b16 v[192:193], v6 offset:49152
    ds_read_b64_tr_b16 v[194:195], v6 offset:50688
    s_lshl_b32 s66, s98, 14
    s_add_u32 s66, s66, s87
    s_mov_b32 m0, s65
    s_nop 0
    buffer_load_dwordx4 v5, s[28:31], s66 offen lds
    v_mfma_f32_32x32x16_bf16 v[48:63], v[148:151], a[96:99], v[48:63]
    ds_read_b64_tr_b16 v[196:197], v6 offset:0
    ds_read_b64_tr_b16 v[198:199], v6 offset:1536
    v_mfma_f32_32x32x16_bf16 v[64:79], v[152:155], a[96:99], v[64:79]
    ds_read_b64_tr_b16 v[200:201], v6 offset:49216
    ds_read_b64_tr_b16 v[202:203], v6 offset:50752
    buffer_load_dwordx4 v20, s[28:31], s66 offen offset:1024 lds
    v_mfma_f32_32x32x16_bf16 v[80:95], v[156:159], a[96:99], v[80:95]
    ds_read_b64_tr_b16 v[204:205], v6 offset:64
    ds_read_b64_tr_b16 v[206:207], v6 offset:1600
    v_mfma_f32_32x32x16_bf16 v[96:111], v[160:163], a[96:99], v[96:111]
    ds_read_b64_tr_b16 v[208:209], v6 offset:49280
    ds_read_b64_tr_b16 v[210:211], v6 offset:50816
    v_mfma_f32_32x32x16_bf16 v[112:127], v[164:167], a[96:99], v[112:127]
    ds_read_b64_tr_b16 v[212:213], v6 offset:128
    ds_read_b64_tr_b16 v[214:215], v6 offset:1664
    s_mul_i32 s56, s64, 2
    s_min_u32 s56, s56, 5
    s_mul_i32 s57, s82, 1
    s_add_u32 s56, s56, s57
    s_lshl_b32 s84, s83, 11
    s_mul_i32 s57, s96, 1
    s_mul_i32 s57, s57, s83
    s_add_u32 s56, s56, s57
    s_mul_i32 s95, s96, 2
    s_mul_i32 s95, s95, s83
    s_lshl_b32 s65, s56, 11
    s_add_u32 s65, s65, 81920
    s_add_u32 s98, s56, 7
    s_lshl_b32 s66, s98, 14
    s_add_u32 s66, s66, s87
    s_add_u32 s66, s66, 704512
    s_mov_b32 m0, s65
    s_nop 0
    buffer_load_dwordx4 v5, s[28:31], s66 offen lds
    s_waitcnt lgkmcnt(12)
    v_mfma_f32_32x32x16_bf16 v[32:47], v[168:171], a[100:103], v[32:47]
    ds_read_b64_tr_b16 v[144:145], v6 offset:52224
    ds_read_b64_tr_b16 v[146:147], v6 offset:53760
    v_mfma_f32_32x32x16_bf16 v[48:63], v[172:175], a[100:103], v[48:63]
    ds_read_b64_tr_b16 v[148:149], v6 offset:3072
    ds_read_b64_tr_b16 v[150:151], v6 offset:4608
    buffer_load_dwordx4 v20, s[28:31], s66 offen offset:1024 lds
    s_sub_u32 s56, s83, s95
    s_add_u32 s98, s98, s56
    s_lshl_b32 s56, s56, 11
    s_add_u32 s65, s65, s56
    v_mfma_f32_32x32x16_bf16 v[64:79], v[176:179], a[100:103], v[64:79]
    ds_read_b64_tr_b16 v[152:153], v6 offset:52288
    ds_read_b64_tr_b16 v[154:155], v6 offset:53824
    v_mfma_f32_32x32x16_bf16 v[80:95], v[180:183], a[100:103], v[80:95]
    ds_read_b64_tr_b16 v[156:157], v6 offset:3136
    ds_read_b64_tr_b16 v[158:159], v6 offset:4672
    v_mfma_f32_32x32x16_bf16 v[96:111], v[184:187], a[100:103], v[96:111]
    ds_read_b64_tr_b16 v[160:161], v6 offset:52352
    ds_read_b64_tr_b16 v[162:163], v6 offset:53888
    s_lshl_b32 s66, s98, 14
    s_add_u32 s66, s66, s87
    s_add_u32 s66, s66, 704512
    s_mov_b32 m0, s65
    s_nop 0
    buffer_load_dwordx4 v5, s[28:31], s66 offen lds
    v_mfma_f32_32x32x16_bf16 v[112:127], v[188:191], a[100:103], v[112:127]
    ds_read_b64_tr_b16 v[164:165], v6 offset:3200
    ds_read_b64_tr_b16 v[166:167], v6 offset:4736
    s_waitcnt lgkmcnt(12)
    v_mfma_f32_32x32x16_bf16 v[32:47], v[192:195], a[104:107], v[32:47]
    s_barrier
    ds_read_b64_tr_b16 v[168:169], v6 offset:55296
    ds_read_b64_tr_b16 v[170:171], v6 offset:56832
    buffer_load_dwordx4 v20, s[28:31], s66 offen offset:1024 lds
    v_mfma_f32_32x32x16_bf16 v[48:63], v[196:199], a[104:107], v[48:63]
    ds_read_b64_tr_b16 v[172:173], v6 offset:6144
    ds_read_b64_tr_b16 v[174:175], v6 offset:7680
    v_mfma_f32_32x32x16_bf16 v[64:79], v[200:203], a[104:107], v[64:79]
    ds_read_b64_tr_b16 v[176:177], v6 offset:55360
    ds_read_b64_tr_b16 v[178:179], v6 offset:56896
    v_mfma_f32_32x32x16_bf16 v[80:95], v[204:207], a[104:107], v[80:95]
    ds_read_b64_tr_b16 v[180:181], v6 offset:6208
    ds_read_b64_tr_b16 v[182:183], v6 offset:7744
    v_mfma_f32_32x32x16_bf16 v[96:111], v[208:211], a[104:107], v[96:111]
    ds_read_b64_tr_b16 v[184:185], v6 offset:55424
    ds_read_b64_tr_b16 v[186:187], v6 offset:56960
    v_mfma_f32_32x32x16_bf16 v[112:127], v[212:215], a[104:107], v[112:127]
    ds_read_b64_tr_b16 v[188:189], v6 offset:6272
    ds_read_b64_tr_b16 v[190:191], v6 offset:7808
    s_waitcnt lgkmcnt(12)
    v_mfma_f32_32x32x16_bf16 v[32:47], v[144:147], a[108:111], v[32:47]
    ds_read_b64_tr_b16 v[192:193], v6 offset:58368
    ds_read_b64_tr_b16 v[194:195], v6 offset:59904
    v_mfma_f32_32x32x16_bf16 v[48:63], v[148:151], a[108:111], v[48:63]
    ds_read_b64_tr_b16 v[196:197], v6 offset:9216
    ds_read_b64_tr_b16 v[198:199], v6 offset:10752
    v_mfma_f32_32x32x16_bf16 v[64:79], v[152:155], a[108:111], v[64:79]
    ds_read_b64_tr_b16 v[200:201], v6 offset:58432
    ds_read_b64_tr_b16 v[202:203], v6 offset:59968
    v_mfma_f32_32x32x16_bf16 v[80:95], v[156:159], a[108:111], v[80:95]
    ds_read_b64_tr_b16 v[204:205], v6 offset:9280
    ds_read_b64_tr_b16 v[206:207], v6 offset:10816
    v_mfma_f32_32x32x16_bf16 v[96:111], v[160:163], a[108:111], v[96:111]
    ds_read_b64_tr_b16 v[208:209], v6 offset:58496
    ds_read_b64_tr_b16 v[210:211], v6 offset:60032
    v_mfma_f32_32x32x16_bf16 v[112:127], v[164:167], a[108:111], v[112:127]
    ds_read_b64_tr_b16 v[212:213], v6 offset:9344
    ds_read_b64_tr_b16 v[214:215], v6 offset:10880
    s_waitcnt vmcnt(19)
    s_waitcnt lgkmcnt(12)
    v_mfma_f32_32x32x16_bf16 v[32:47], v[168:171], a[112:115], v[32:47]
    ds_read_b64_tr_b16 v[144:145], v6 offset:61440
    ds_read_b64_tr_b16 v[146:147], v6 offset:62976
    v_mfma_f32_32x32x16_bf16 v[48:63], v[172:175], a[112:115], v[48:63]
    ds_read_b64_tr_b16 v[148:149], v6 offset:12288
    ds_read_b64_tr_b16 v[150:151], v6 offset:13824
    v_mfma_f32_32x32x16_bf16 v[64:79], v[176:179], a[112:115], v[64:79]
    ds_read_b64_tr_b16 v[152:153], v6 offset:61504
    ds_read_b64_tr_b16 v[154:155], v6 offset:63040
    v_mfma_f32_32x32x16_bf16 v[80:95], v[180:183], a[112:115], v[80:95]
    ds_read_b64_tr_b16 v[156:157], v6 offset:12352
    ds_read_b64_tr_b16 v[158:159], v6 offset:13888
    s_mul_i32 s56, s64, 4
    s_min_u32 s56, s56, 11
    s_mul_i32 s57, s82, 3
    s_add_u32 s56, s56, s57
    s_lshl_b32 s84, s83, 11
    s_mul_i32 s57, s96, 2
    s_mul_i32 s57, s57, s83
    s_add_u32 s56, s56, s57
    s_mul_i32 s95, s96, 4
    s_mul_i32 s95, s95, s83
    s_lshl_b32 s65, s56, 11
    s_add_u32 s65, s65, 98304
    s_add_u32 s98, s56, 14
    s_lshl_b32 s66, s98, 14
    s_add_u32 s66, s66, s87
    s_mov_b32 m0, s65
    s_nop 0
    buffer_load_dwordx4 v5, s[28:31], s66 offen lds
    v_mfma_f32_32x32x16_bf16 v[96:111], v[184:187], a[112:115], v[96:111]
    ds_read_b64_tr_b16 v[160:161], v6 offset:61568
    ds_read_b64_tr_b16 v[162:163], v6 offset:63104
    v_mfma_f32_32x32x16_bf16 v[112:127], v[188:191], a[112:115], v[112:127]
    ds_read_b64_tr_b16 v[164:165], v6 offset:12416
    ds_read_b64_tr_b16 v[166:167], v6 offset:13952
    s_waitcnt vmcnt(18)
    s_waitcnt lgkmcnt(12)
    v_mfma_f32_32x32x16_bf16 v[32:47], v[192:195], a[116:119], v[32:47]
    ds_read_b64_tr_b16 v[168:169], v6 offset:64512
    ds_read_b64_tr_b16 v[170:171], v7 offset:512
    buffer_load_dwordx4 v20, s[28:31], s66 offen offset:1024 lds
    s_add_u32 s98, s98, s83
    s_add_u32 s65, s65, s84
    v_mfma_f32_32x32x16_bf16 v[48:63], v[196:199], a[116:119], v[48:63]
    ds_read_b64_tr_b16 v[172:173], v6 offset:15360
    ds_read_b64_tr_b16 v[174:175], v6 offset:16896
    v_mfma_f32_32x32x16_bf16 v[64:79], v[200:203], a[116:119], v[64:79]
    ds_read_b64_tr_b16 v[176:177], v6 offset:64576
    ds_read_b64_tr_b16 v[178:179], v7 offset:576
    v_mfma_f32_32x32x16_bf16 v[80:95], v[204:207], a[116:119], v[80:95]
    ds_read_b64_tr_b16 v[180:181], v6 offset:15424
    ds_read_b64_tr_b16 v[182:183], v6 offset:16960
    s_lshl_b32 s66, s98, 14
    s_add_u32 s66, s66, s87
    s_mov_b32 m0, s65
    s_nop 0
    buffer_load_dwordx4 v5, s[28:31], s66 offen lds
    v_mfma_f32_32x32x16_bf16 v[96:111], v[208:211], a[116:119], v[96:111]
    ds_read_b64_tr_b16 v[184:185], v6 offset:64640
    ds_read_b64_tr_b16 v[186:187], v7 offset:640
    v_mfma_f32_32x32x16_bf16 v[112:127], v[212:215], a[116:119], v[112:127]
    ds_read_b64_tr_b16 v[188:189], v6 offset:15488
    ds_read_b64_tr_b16 v[190:191], v6 offset:17024
    s_waitcnt vmcnt(17)
    s_waitcnt lgkmcnt(12)
    v_mfma_f32_32x32x16_bf16 v[32:47], v[144:147], a[120:123], v[32:47]
    v_mfma_f32_32x32x16_bf16 v[48:63], v[148:151], a[120:123], v[48:63]
    buffer_load_dwordx4 v20, s[28:31], s66 offen offset:1024 lds
    s_sub_u32 s56, s83, s95
    s_add_u32 s98, s98, s56
    s_lshl_b32 s56, s56, 11
    s_add_u32 s65, s65, s56
    v_mfma_f32_32x32x16_bf16 v[64:79], v[152:155], a[120:123], v[64:79]
    v_mfma_f32_32x32x16_bf16 v[80:95], v[156:159], a[120:123], v[80:95]
    v_mfma_f32_32x32x16_bf16 v[96:111], v[160:163], a[120:123], v[96:111]
    s_lshl_b32 s66, s98, 14
    s_add_u32 s66, s66, s87
    s_mov_b32 m0, s65
    s_nop 0
    buffer_load_dwordx4 v5, s[28:31], s66 offen lds
    v_mfma_f32_32x32x16_bf16 v[112:127], v[164:167], a[120:123], v[112:127]
    s_waitcnt vmcnt(15)
    s_waitcnt lgkmcnt(0)
    v_mfma_f32_32x32x16_bf16 v[32:47], v[168:171], a[124:127], v[32:47]
    v_mfma_f32_32x32x16_bf16 v[48:63], v[172:175], a[124:127], v[48:63]
    buffer_load_dwordx4 v20, s[28:31], s66 offen offset:1024 lds
    s_add_u32 s98, s98, s83
    s_add_u32 s65, s65, s84
    v_mfma_f32_32x32x16_bf16 v[64:79], v[176:179], a[124:127], v[64:79]
    v_mfma_f32_32x32x16_bf16 v[80:95], v[180:183], a[124:127], v[80:95]
    v_mfma_f32_32x32x16_bf16 v[96:111], v[184:187], a[124:127], v[96:111]
    v_mfma_f32_32x32x16_bf16 v[112:127], v[188:191], a[124:127], v[112:127]
    s_barrier
    s_nop 2
    v_mul_f32 v128, v32, v32
    v_mul_f32 v129, v33, v33
    v_fma_f32 v128, v128, v29, v28
    v_fma_f32 v129, v129, v29, v28
    v_mul_f32 v128, v128, v32
    v_mul_f32 v129, v129, v33
    v_exp_f32 v128, v128
    v_exp_f32 v129, v129
    v_mul_f32 v48, v32, v48
    v_mul_f32 v49, v33, v49
    v_add_f32 v128, 1.0, v128
    v_add_f32 v129, 1.0, v129
    v_rcp_f32 v128, v128
    v_rcp_f32 v129, v129
    v_mul_f32 v48, v48, v128
    v_mul_f32 v49, v49, v129
    s_lshl_b32 s66, s98, 14
    s_add_u32 s66, s66, s87
    s_mov_b32 m0, s65
    s_nop 0
    buffer_load_dwordx4 v5, s[28:31], s66 offen lds
    v_cvt_pk_bf16_f32 v136, v48, v49
    v_mul_f32 v130, v34, v34
    v_mul_f32 v131, v35, v35
    v_fma_f32 v130, v130, v29, v28
    v_fma_f32 v131, v131, v29, v28
    v_mul_f32 v130, v130, v34
    v_mul_f32 v131, v131, v35
    v_exp_f32 v130, v130
    v_exp_f32 v131, v131
    v_mul_f32 v50, v34, v50
    v_mul_f32 v51, v35, v51
    v_add_f32 v130, 1.0, v130
    v_add_f32 v131, 1.0, v131
    v_rcp_f32 v130, v130
    v_rcp_f32 v131, v131
    buffer_load_dwordx4 v20, s[28:31], s66 offen offset:1024 lds
    v_mul_f32 v50, v50, v130
    v_mul_f32 v51, v51, v131
    v_cvt_pk_bf16_f32 v137, v50, v51
    v_mul_f32 v128, v36, v36
    v_mul_f32 v129, v37, v37
    v_fma_f32 v128, v128, v29, v28
    v_fma_f32 v129, v129, v29, v28
    v_mul_f32 v128, v128, v36
    v_mul_f32 v129, v129, v37
    v_exp_f32 v128, v128
    v_exp_f32 v129, v129
    v_mul_f32 v52, v36, v52
    v_mul_f32 v53, v37, v53
    v_add_f32 v128, 1.0, v128
    v_add_f32 v129, 1.0, v129
    s_mul_i32 s56, s64, 4
    s_min_u32 s56, s56, 11
    s_mul_i32 s57, s82, 3
    s_add_u32 s56, s56, s57
    s_lshl_b32 s84, s83, 11
    s_mul_i32 s57, s96, 2
    s_mul_i32 s57, s57, s83
    s_add_u32 s56, s56, s57
    s_mul_i32 s95, s96, 4
    s_mul_i32 s95, s95, s83
    s_lshl_b32 s65, s56, 11
    s_add_u32 s65, s65, 129024
    s_add_u32 s98, s56, 14
    s_lshl_b32 s66, s98, 14
    s_add_u32 s66, s66, s87
    s_add_u32 s66, s66, 704512
    s_mov_b32 m0, s65
    s_nop 0
    buffer_load_dwordx4 v5, s[28:31], s66 offen lds
    v_rcp_f32 v128, v128
    v_rcp_f32 v129, v129
    v_mul_f32 v52, v52, v128
    v_mul_f32 v53, v53, v129
    v_cvt_pk_bf16_f32 v138, v52, v53
    v_mul_f32 v130, v38, v38
    v_mul_f32 v131, v39, v39
    v_fma_f32 v130, v130, v29, v28
    v_fma_f32 v131, v131, v29, v28
    v_mul_f32 v130, v130, v38
    v_mul_f32 v131, v131, v39
    v_exp_f32 v130, v130
    v_exp_f32 v131, v131
    v_mul_f32 v54, v38, v54
    v_mul_f32 v55, v39, v55
    buffer_load_dwordx4 v20, s[28:31], s66 offen offset:1024 lds
    s_add_u32 s98, s98, s83
    s_add_u32 s65, s65, s84
    v_add_f32 v130, 1.0, v130
    v_add_f32 v131, 1.0, v131
    v_rcp_f32 v130, v130
    v_rcp_f32 v131, v131
    v_mul_f32 v54, v54, v130
    v_mul_f32 v55, v55, v131
    v_cvt_pk_bf16_f32 v139, v54, v55
    v_mul_f32 v128, v40, v40
    v_mul_f32 v129, v41, v41
    v_fma_f32 v128, v128, v29, v28
    v_fma_f32 v129, v129, v29, v28
    v_mul_f32 v128, v128, v40
    v_mul_f32 v129, v129, v41
    v_exp_f32 v128, v128
    v_exp_f32 v129, v129
    s_lshl_b32 s66, s98, 14
    s_add_u32 s66, s66, s87
    s_add_u32 s66, s66, 704512
    s_mov_b32 m0, s65
    s_nop 0
    buffer_load_dwordx4 v5, s[28:31], s66 offen lds
    v_mul_f32 v56, v40, v56
    v_mul_f32 v57, v41, v57
    v_add_f32 v128, 1.0, v128
    v_add_f32 v129, 1.0, v129
    v_rcp_f32 v128, v128
    v_rcp_f32 v129, v129
    v_mul_f32 v56, v56, v128
    v_mul_f32 v57, v57, v129
    v_cvt_pk_bf16_f32 v140, v56, v57
    v_mul_f32 v130, v42, v42
    v_mul_f32 v131, v43, v43
    v_fma_f32 v130, v130, v29, v28
    v_fma_f32 v131, v131, v29, v28
    v_mul_f32 v130, v130, v42
    v_mul_f32 v131, v131, v43
    buffer_load_dwordx4 v20, s[28:31], s66 offen offset:1024 lds
    s_sub_u32 s56, s83, s95
    s_add_u32 s98, s98, s56
    s_lshl_b32 s56, s56, 11
    s_add_u32 s65, s65, s56
    v_exp_f32 v130, v130
    v_exp_f32 v131, v131
    v_mul_f32 v58, v42, v58
    v_mul_f32 v59, v43, v59
    v_add_f32 v130, 1.0, v130
    v_add_f32 v131, 1.0, v131
    v_rcp_f32 v130, v130
    v_rcp_f32 v131, v131
    v_mul_f32 v58, v58, v130
    v_mul_f32 v59, v59, v131
    v_cvt_pk_bf16_f32 v141, v58, v59
    v_mul_f32 v128, v44, v44
    v_mul_f32 v129, v45, v45
    v_fma_f32 v128, v128, v29, v28
    v_fma_f32 v129, v129, v29, v28
    s_lshl_b32 s66, s98, 14
    s_add_u32 s66, s66, s87
    s_add_u32 s66, s66, 704512
    s_mov_b32 m0, s65
    s_nop 0
    buffer_load_dwordx4 v5, s[28:31], s66 offen lds
    v_mul_f32 v128, v128, v44
    v_mul_f32 v129, v129, v45
    v_exp_f32 v128, v128
    v_exp_f32 v129, v129
    v_mul_f32 v60, v44, v60
    v_mul_f32 v61, v45, v61
    v_add_f32 v128, 1.0, v128
    v_add_f32 v129, 1.0, v129
    v_rcp_f32 v128, v128
    v_rcp_f32 v129, v129
    v_mul_f32 v60, v60, v128
    v_mul_f32 v61, v61, v129
    v_cvt_pk_bf16_f32 v142, v60, v61
    v_mul_f32 v130, v46, v46
    v_mul_f32 v131, v47, v47
    buffer_load_dwordx4 v20, s[28:31], s66 offen offset:1024 lds
    s_add_u32 s98, s98, s83
    s_add_u32 s65, s65, s84
    v_fma_f32 v130, v130, v29, v28
    v_fma_f32 v131, v131, v29, v28
    v_mul_f32 v130, v130, v46
    v_mul_f32 v131, v131, v47
    v_exp_f32 v130, v130
    v_exp_f32 v131, v131
    v_mul_f32 v62, v46, v62
    v_mul_f32 v63, v47, v63
    v_add_f32 v130, 1.0, v130
    v_add_f32 v131, 1.0, v131
    v_rcp_f32 v130, v130
    v_rcp_f32 v131, v131
    v_mul_f32 v62, v62, v130
    v_mul_f32 v63, v63, v131
    v_cvt_pk_bf16_f32 v143, v62, v63
    s_lshl_b32 s66, s98, 14
    s_add_u32 s66, s66, s87
    s_add_u32 s66, s66, 704512
    s_mov_b32 m0, s65
    s_nop 0
    buffer_load_dwordx4 v5, s[28:31], s66 offen lds
    s_mul_i32 s59, s47, 88064
    s_lshl_b32 s60, s68, 11
    s_add_u32 s59, s59, s60
    s_add_u32 s59, s59, 12582912
    buffer_store_dwordx4 v[136:139], v2, s[40:43], s59 offen sc1
    buffer_store_dwordx4 v[140:143], v2, s[40:43], s59 offen offset:1024 sc1
    v_mul_f32 v128, v64, v64
    v_mul_f32 v129, v65, v65
    v_fma_f32 v128, v128, v29, v28
    v_fma_f32 v129, v129, v29, v28
    v_mul_f32 v128, v128, v64
    v_mul_f32 v129, v129, v65
    v_exp_f32 v128, v128
    v_exp_f32 v129, v129
    v_mul_f32 v80, v64, v80
    v_mul_f32 v81, v65, v81
    v_add_f32 v128, 1.0, v128
    v_add_f32 v129, 1.0, v129
    v_rcp_f32 v128, v128
    v_rcp_f32 v129, v129
    v_mul_f32 v80, v80, v128
    v_mul_f32 v81, v81, v129
    buffer_load_dwordx4 v20, s[28:31], s66 offen offset:1024 lds
    v_cvt_pk_bf16_f32 v144, v80, v81
    v_mul_f32 v130, v66, v66
    v_mul_f32 v131, v67, v67
    v_fma_f32 v130, v130, v29, v28
    v_fma_f32 v131, v131, v29, v28
    v_mul_f32 v130, v130, v66
    v_mul_f32 v131, v131, v67
    v_exp_f32 v130, v130
    v_exp_f32 v131, v131
    v_mul_f32 v82, v66, v82
    v_mul_f32 v83, v67, v83
    v_add_f32 v130, 1.0, v130
    v_add_f32 v131, 1.0, v131
    v_rcp_f32 v130, v130
    v_rcp_f32 v131, v131
    s_mul_i32 s56, s64, 1
    s_lshl_b32 s65, s56, 11
    s_add_u32 s65, s65, 0
    s_add_u32 s98, s56, 29
    s_lshl_b32 s66, s98, 14
    s_add_u32 s66, s66, s87
    s_mov_b32 m0, s65
    s_nop 0
    buffer_load_dwordx4 v5, s[28:31], s66 offen lds
    v_mul_f32 v82, v82, v130
    v_mul_f32 v83, v83, v131
    v_cvt_pk_bf16_f32 v145, v82, v83
    v_mul_f32 v128, v68, v68
    v_mul_f32 v129, v69, v69
    v_fma_f32 v128, v128, v29, v28
    v_fma_f32 v129, v129, v29, v28
    v_mul_f32 v128, v128, v68
    v_mul_f32 v129, v129, v69
    v_exp_f32 v128, v128
    v_exp_f32 v129, v129
    v_mul_f32 v84, v68, v84
    v_mul_f32 v85, v69, v85
    v_add_f32 v128, 1.0, v128
    v_add_f32 v129, 1.0, v129
    buffer_load_dwordx4 v20, s[28:31], s66 offen offset:1024 lds
    v_rcp_f32 v128, v128
    v_rcp_f32 v129, v129
    v_mul_f32 v84, v84, v128
    v_mul_f32 v85, v85, v129
    v_cvt_pk_bf16_f32 v146, v84, v85
    v_mul_f32 v130, v70, v70
    v_mul_f32 v131, v71, v71
    v_fma_f32 v130, v130, v29, v28
    v_fma_f32 v131, v131, v29, v28
    v_mul_f32 v130, v130, v70
    v_mul_f32 v131, v131, v71
    v_exp_f32 v130, v130
    v_exp_f32 v131, v131
    v_mul_f32 v86, v70, v86
    v_mul_f32 v87, v71, v87
    s_mul_i32 s56, s64, 1
    s_lshl_b32 s65, s56, 11
    s_add_u32 s65, s65, 8192
    s_add_u32 s98, s56, 29
    s_lshl_b32 s66, s98, 14
    s_add_u32 s66, s66, s87
    s_add_u32 s66, s66, 704512
    s_mov_b32 m0, s65
    s_nop 0
    buffer_load_dwordx4 v5, s[28:31], s66 offen lds
    v_add_f32 v130, 1.0, v130
    v_add_f32 v131, 1.0, v131
    v_rcp_f32 v130, v130
    v_rcp_f32 v131, v131
    v_mul_f32 v86, v86, v130
    v_mul_f32 v87, v87, v131
    v_cvt_pk_bf16_f32 v147, v86, v87
    v_mul_f32 v128, v72, v72
    v_mul_f32 v129, v73, v73
    v_fma_f32 v128, v128, v29, v28
    v_fma_f32 v129, v129, v29, v28
    v_mul_f32 v128, v128, v72
    v_mul_f32 v129, v129, v73
    v_exp_f32 v128, v128
    v_exp_f32 v129, v129
    buffer_load_dwordx4 v20, s[28:31], s66 offen offset:1024 lds
    v_mul_f32 v88, v72, v88
    v_mul_f32 v89, v73, v89
    v_add_f32 v128, 1.0, v128
    v_add_f32 v129, 1.0, v129
    v_rcp_f32 v128, v128
    v_rcp_f32 v129, v129
    v_mul_f32 v88, v88, v128
    v_mul_f32 v89, v89, v129
    v_cvt_pk_bf16_f32 v148, v88, v89
    v_mul_f32 v130, v74, v74
    v_mul_f32 v131, v75, v75
    v_fma_f32 v130, v130, v29, v28
    v_fma_f32 v131, v131, v29, v28
    v_mul_f32 v130, v130, v74
    v_mul_f32 v131, v131, v75
    s_mul_i32 s56, s64, 1
    s_lshl_b32 s65, s56, 11
    s_add_u32 s65, s65, 49152
    s_add_u32 s98, s56, 33
    s_lshl_b32 s66, s98, 14
    s_add_u32 s66, s66, s87
    s_mov_b32 m0, s65
    s_nop 0
    buffer_load_dwordx4 v5, s[28:31], s66 offen lds
    v_exp_f32 v130, v130
    v_exp_f32 v131, v131
    v_mul_f32 v90, v74, v90
    v_mul_f32 v91, v75, v91
    v_add_f32 v130, 1.0, v130
    v_add_f32 v131, 1.0, v131
    v_rcp_f32 v130, v130
    v_rcp_f32 v131, v131
    v_mul_f32 v90, v90, v130
    v_mul_f32 v91, v91, v131
    v_cvt_pk_bf16_f32 v149, v90, v91
    v_mul_f32 v128, v76, v76
    v_mul_f32 v129, v77, v77
    v_fma_f32 v128, v128, v29, v28
    v_fma_f32 v129, v129, v29, v28
    buffer_load_dwordx4 v20, s[28:31], s66 offen offset:1024 lds
    v_mul_f32 v128, v128, v76
    v_mul_f32 v129, v129, v77
    v_exp_f32 v128, v128
    v_exp_f32 v129, v129
    v_mul_f32 v92, v76, v92
    v_mul_f32 v93, v77, v93
    v_add_f32 v128, 1.0, v128
    v_add_f32 v129, 1.0, v129
    v_rcp_f32 v128, v128
    v_rcp_f32 v129, v129
    v_mul_f32 v92, v92, v128
    v_mul_f32 v93, v93, v129
    v_cvt_pk_bf16_f32 v150, v92, v93
    v_mul_f32 v130, v78, v78
    v_mul_f32 v131, v79, v79
    s_mul_i32 s56, s64, 1
    s_lshl_b32 s65, s56, 11
    s_add_u32 s65, s65, 57344
    s_add_u32 s98, s56, 33
    s_lshl_b32 s66, s98, 14
    s_add_u32 s66, s66, s87
    s_add_u32 s66, s66, 704512
    s_mov_b32 m0, s65
    s_nop 0
    buffer_load_dwordx4 v5, s[28:31], s66 offen lds
    v_fma_f32 v130, v130, v29, v28
    v_fma_f32 v131, v131, v29, v28
    v_mul_f32 v130, v130, v78
    v_mul_f32 v131, v131, v79
    v_exp_f32 v130, v130
    v_exp_f32 v131, v131
    v_mul_f32 v94, v78, v94
    v_mul_f32 v95, v79, v95
    v_add_f32 v130, 1.0, v130
    v_add_f32 v131, 1.0, v131
    v_rcp_f32 v130, v130
    v_rcp_f32 v131, v131
    v_mul_f32 v94, v94, v130
    v_mul_f32 v95, v95, v131
    v_cvt_pk_bf16_f32 v151, v94, v95
    buffer_load_dwordx4 v20, s[28:31], s66 offen offset:1024 lds
    s_mul_i32 s59, s47, 88064
    s_lshl_b32 s60, s68, 11
    s_add_u32 s59, s59, s60
    s_add_u32 s59, s59, 12584960
    buffer_store_dwordx4 v[144:147], v2, s[40:43], s59 offen sc1
    buffer_store_dwordx4 v[148:151], v2, s[40:43], s59 offen offset:1024 sc1
    v_mul_f32 v128, v96, v96
    v_mul_f32 v129, v97, v97
    v_fma_f32 v128, v128, v29, v28
    v_fma_f32 v129, v129, v29, v28
    v_mul_f32 v128, v128, v96
    v_mul_f32 v129, v129, v97
    v_exp_f32 v128, v128
    v_exp_f32 v129, v129
    v_mul_f32 v112, v96, v112
    v_mul_f32 v113, v97, v113
    v_add_f32 v128, 1.0, v128
    v_add_f32 v129, 1.0, v129
    v_rcp_f32 v128, v128
    v_rcp_f32 v129, v129
    v_mul_f32 v112, v112, v128
    v_mul_f32 v113, v113, v129
    v_cvt_pk_bf16_f32 v136, v112, v113
    v_mul_f32 v130, v98, v98
    v_mul_f32 v131, v99, v99
    v_fma_f32 v130, v130, v29, v28
    v_fma_f32 v131, v131, v29, v28
    v_mul_f32 v130, v130, v98
    v_mul_f32 v131, v131, v99
    v_exp_f32 v130, v130
    v_exp_f32 v131, v131
    v_mul_f32 v114, v98, v114
    v_mul_f32 v115, v99, v115
    v_add_f32 v130, 1.0, v130
    v_add_f32 v131, 1.0, v131
    v_rcp_f32 v130, v130
    v_rcp_f32 v131, v131
    v_mul_f32 v114, v114, v130
    v_mul_f32 v115, v115, v131
    v_cvt_pk_bf16_f32 v137, v114, v115
    v_mul_f32 v128, v100, v100
    v_mul_f32 v129, v101, v101
    v_fma_f32 v128, v128, v29, v28
    v_fma_f32 v129, v129, v29, v28
    v_mul_f32 v128, v128, v100
    v_mul_f32 v129, v129, v101
    v_exp_f32 v128, v128
    v_exp_f32 v129, v129
    v_mul_f32 v116, v100, v116
    v_mul_f32 v117, v101, v117
    v_add_f32 v128, 1.0, v128
    v_add_f32 v129, 1.0, v129
    v_rcp_f32 v128, v128
    v_rcp_f32 v129, v129
    v_mul_f32 v116, v116, v128
    v_mul_f32 v117, v117, v129
    v_cvt_pk_bf16_f32 v138, v116, v117
    v_mul_f32 v130, v102, v102
    v_mul_f32 v131, v103, v103
    v_fma_f32 v130, v130, v29, v28
    v_fma_f32 v131, v131, v29, v28
    v_mul_f32 v130, v130, v102
    v_mul_f32 v131, v131, v103
    v_exp_f32 v130, v130
    v_exp_f32 v131, v131
    v_mul_f32 v118, v102, v118
    v_mul_f32 v119, v103, v119
    v_add_f32 v130, 1.0, v130
    v_add_f32 v131, 1.0, v131
    v_rcp_f32 v130, v130
    v_rcp_f32 v131, v131
    v_mul_f32 v118, v118, v130
    v_mul_f32 v119, v119, v131
    v_cvt_pk_bf16_f32 v139, v118, v119
    v_mul_f32 v128, v104, v104
    v_mul_f32 v129, v105, v105
    v_fma_f32 v128, v128, v29, v28
    v_fma_f32 v129, v129, v29, v28
    v_mul_f32 v128, v128, v104
    v_mul_f32 v129, v129, v105
    v_exp_f32 v128, v128
    v_exp_f32 v129, v129
    v_mul_f32 v120, v104, v120
    v_mul_f32 v121, v105, v121
    v_add_f32 v128, 1.0, v128
    v_add_f32 v129, 1.0, v129
    v_rcp_f32 v128, v128
    v_rcp_f32 v129, v129
    v_mul_f32 v120, v120, v128
    v_mul_f32 v121, v121, v129
    v_cvt_pk_bf16_f32 v140, v120, v121
    v_mul_f32 v130, v106, v106
    v_mul_f32 v131, v107, v107
    v_fma_f32 v130, v130, v29, v28
    v_fma_f32 v131, v131, v29, v28
    v_mul_f32 v130, v130, v106
    v_mul_f32 v131, v131, v107
    v_exp_f32 v130, v130
    v_exp_f32 v131, v131
    v_mul_f32 v122, v106, v122
    v_mul_f32 v123, v107, v123
    v_add_f32 v130, 1.0, v130
    v_add_f32 v131, 1.0, v131
    v_rcp_f32 v130, v130
    v_rcp_f32 v131, v131
    v_mul_f32 v122, v122, v130
    v_mul_f32 v123, v123, v131
    v_cvt_pk_bf16_f32 v141, v122, v123
    v_mul_f32 v128, v108, v108
    v_mul_f32 v129, v109, v109
    v_fma_f32 v128, v128, v29, v28
    v_fma_f32 v129, v129, v29, v28
    v_mul_f32 v128, v128, v108
    v_mul_f32 v129, v129, v109
    v_exp_f32 v128, v128
    v_exp_f32 v129, v129
    v_mul_f32 v124, v108, v124
    v_mul_f32 v125, v109, v125
    v_add_f32 v128, 1.0, v128
    v_add_f32 v129, 1.0, v129
    v_rcp_f32 v128, v128
    v_rcp_f32 v129, v129
    v_mul_f32 v124, v124, v128
    v_mul_f32 v125, v125, v129
    v_cvt_pk_bf16_f32 v142, v124, v125
    v_mul_f32 v130, v110, v110
    v_mul_f32 v131, v111, v111
    v_fma_f32 v130, v130, v29, v28
    v_fma_f32 v131, v131, v29, v28
    v_mul_f32 v130, v130, v110
    v_mul_f32 v131, v131, v111
    v_exp_f32 v130, v130
    v_exp_f32 v131, v131
    v_mul_f32 v126, v110, v126
    v_mul_f32 v127, v111, v127
    v_add_f32 v130, 1.0, v130
    v_add_f32 v131, 1.0, v131
    v_rcp_f32 v130, v130
    v_rcp_f32 v131, v131
    v_mul_f32 v126, v126, v130
    v_mul_f32 v127, v127, v131
    v_cvt_pk_bf16_f32 v143, v126, v127
    s_mul_i32 s59, s47, 88064
    s_lshl_b32 s60, s68, 11
    s_add_u32 s59, s59, s60
    s_add_u32 s59, s59, 12587008
    buffer_store_dwordx4 v[136:139], v2, s[40:43], s59 offen sc1
    buffer_store_dwordx4 v[140:143], v2, s[40:43], s59 offen offset:1024 sc1
    s_waitcnt vmcnt(0)
    s_lshl_b32 s57, s44, 9
    s_add_u32 s57, s57, 19955712
    s_lshl_b32 s58, s45, 2
    s_add_u32 s58, s58, s46
    s_lshl_b32 s58, s58, 3
    s_add_u32 s58, s58, s57
    v_mov_b32 v12, s48
    v_mov_b32 v13, 0
    s_mov_b64 exec, 1
    s_cmp_eq_u32 s49, 1
    s_cbranch_scc0 L_fs_86
    buffer_store_dword v12, v13, s[40:43], s58 offen
    s_branch L_fe_87
L_fs_86:
    buffer_store_dword v12, v13, s[40:43], s58 offen sc1
L_fe_87:
    s_mov_b64 exec, -1
    s_cmp_eq_u32 s46, 0
    s_cbranch_scc1 L_w0_88
    s_branch L_we_89
L_w0_88:
    v_lshlrev_b32 v12, 3, v1
    s_mov_b32 s67, 0
L_poll_90:
    buffer_load_dword v13, v12, s[40:43], s57 offen sc1
    s_waitcnt vmcnt(0)
    v_cmp_eq_u32 vcc, s48, v13
    s_add_u32 s67, s67, 1
    s_cmp_gt_u32 s67, 400000
    s_cbranch_scc1 L_polld_91
    s_cmp_eq_u64 vcc, -1
    s_cbranch_scc0 L_poll_90
L_polld_91:
    s_cmp_gt_u32 s67, 400000
    s_cselect_b32 s56, 1, 0
    s_or_b32 s69, s69, s56
L_we_89:
    s_barrier
    s_mul_i32 s89, s51, 88064
    s_mul_i32 s57, s52, 44032
    s_add_u32 s89, s89, s57
    s_add_u32 s89, s89, 12582912
    s_mov_b32 s64, s46
    s_add_u32 s90, s89, 0
    buffer_load_dwordx4 a[0:3], v2, s[40:43], s90 offen sc1
    buffer_load_dwordx4 a[4:7], v2, s[40:43], s90 offen offset:1024 sc1
    buffer_load_dwordx4 a[8:11], v2, s[40:43], s90 offen offset:2048 sc1
    buffer_load_dwordx4 a[12:15], v2, s[40:43], s90 offen offset:3072 sc1
    s_add_u32 s90, s89, 4096
    buffer_load_dwordx4 a[16:19], v2, s[40:43], s90 offen sc1
    buffer_load_dwordx4 a[20:23], v2, s[40:43], s90 offen offset:1024 sc1
    buffer_load_dwordx4 a[24:27], v2, s[40:43], s90 offen offset:2048 sc1
    buffer_load_dwordx4 a[28:31], v2, s[40:43], s90 offen offset:3072 sc1
    s_add_u32 s90, s89, 8192
    buffer_load_dwordx4 a[32:35], v2, s[40:43], s90 offen sc1
    buffer_load_dwordx4 a[36:39], v2, s[40:43], s90 offen offset:1024 sc1
    buffer_load_dwordx4 a[40:43], v2, s[40:43], s90 offen offset:2048 sc1
    buffer_load_dwordx4 a[44:47], v2, s[40:43], s90 offen offset:3072 sc1
    v_lshrrev_b32 v12, 5, v1
    v_lshlrev_b32 v12, 2, v12
    v_bfe_u32 v13, v1, 2, 2
    v_add_u32 v12, v12, v13
    v_lshlrev_b32 v12, 7, v12
    v_lshrrev_b32 v13, 1, v13
    v_xor_b32 v13, s52, v13
    v_lshl_add_u32 v12, v13, 6, v12
    v_bfe_u32 v13, v1, 4, 1
    v_lshl_add_u32 v12, v13, 5, v12
    v_and_b32 v13, 3, v1
    v_lshl_add_u32 v22, v13, 3, v12
    v_xor_b32 v23, 64, v22
    s_mul_i32 s56, s52, 14336
    s_add_u32 s56, s56, 18432
    v_add_u32 v6, s56, v22
    v_add_u32 v7, s56, v23
    s_mul_i32 s56, s52, 14336
    s_add_u32 s56, s56, 67584
    v_add_u32 v8, s56, v22
    v_add_u32 v9, s56, v23
    s_mul_i32 s56, s52, 30720
    s_add_u32 s56, s56, 98304
    v_add_u32 v10, s56, v22
    v_add_u32 v11, s56, v23
    s_mul_i32 s56, s52, 8192
    s_add_u32 s56, s56, 0
    v_add_u32 v30, s56, v22
    v_add_u32 v31, s56, v23
    s_mul_i32 s56, s52, 8192
    s_add_u32 s56, s56, 49152
    v_add_u32 v28, s56, v22
    v_add_u32 v29, s56, v23
    ds_read_b64_tr_b16 v[64:65], v6 offset:0
    ds_read_b64_tr_b16 v[66:67], v6 offset:1024
    ds_read_b64_tr_b16 v[68:69], v7 offset:0
    ds_read_b64_tr_b16 v[70:71], v7 offset:1024
    ds_read_b64_tr_b16 v[72:73], v6 offset:2048
    ds_read_b64_tr_b16 v[74:75], v6 offset:3072
    ds_read_b64_tr_b16 v[76:77], v7 offset:2048
    ds_read_b64_tr_b16 v[78:79], v7 offset:3072
    s_waitcnt vmcnt(11)
    s_waitcnt lgkmcnt(4)
    v_mfma_f32_32x32x16_bf16 v[32:47], v[64:67], a[0:3], 0
    ds_read_b64_tr_b16 v[80:81], v6 offset:4096
    ds_read_b64_tr_b16 v[82:83], v6 offset:5120
    s_add_u32 s90, s89, 12288
    buffer_load_dwordx4 a[48:51], v2, s[40:43], s90 offen sc1
    v_mfma_f32_32x32x16_bf16 v[48:63], v[68:71], a[0:3], 0
    ds_read_b64_tr_b16 v[84:85], v7 offset:4096
    ds_read_b64_tr_b16 v[86:87], v7 offset:5120
    s_waitcnt vmcnt(11)
    s_waitcnt lgkmcnt(4)
    v_mfma_f32_32x32x16_bf16 v[32:47], v[72:75], a[4:7], v[32:47]
    ds_read_b64_tr_b16 v[64:65], v6 offset:6144
    ds_read_b64_tr_b16 v[66:67], v6 offset:7168
    buffer_load_dwordx4 a[52:55], v2, s[40:43], s90 offen offset:1024 sc1
    v_mfma_f32_32x32x16_bf16 v[48:63], v[76:79], a[4:7], v[48:63]
    ds_read_b64_tr_b16 v[68:69], v7 offset:6144
    ds_read_b64_tr_b16 v[70:71], v7 offset:7168
    s_waitcnt vmcnt(11)
    s_waitcnt lgkmcnt(4)
    v_mfma_f32_32x32x16_bf16 v[32:47], v[80:83], a[8:11], v[32:47]
    ds_read_b64_tr_b16 v[72:73], v6 offset:8192
    ds_read_b64_tr_b16 v[74:75], v6 offset:9216
    buffer_load_dwordx4 a[56:59], v2, s[40:43], s90 offen offset:2048 sc1
    v_mfma_f32_32x32x16_bf16 v[48:63], v[84:87], a[8:11], v[48:63]
    ds_read_b64_tr_b16 v[76:77], v7 offset:8192
    ds_read_b64_tr_b16 v[78:79], v7 offset:9216
    s_waitcnt vmcnt(11)
    s_waitcnt lgkmcnt(4)
    v_mfma_f32_32x32x16_bf16 v[32:47], v[64:67], a[12:15], v[32:47]
    ds_read_b64_tr_b16 v[80:81], v6 offset:10240
    ds_read_b64_tr_b16 v[82:83], v6 offset:11264
    buffer_load_dwordx4 a[60:63], v2, s[40:43], s90 offen offset:3072 sc1
    v_mfma_f32_32x32x16_bf16 v[48:63], v[68:71], a[12:15], v[48:63]
    ds_read_b64_tr_b16 v[84:85], v7 offset:10240
    ds_read_b64_tr_b16 v[86:87], v7 offset:11264
    s_waitcnt vmcnt(11)
    s_waitcnt lgkmcnt(4)
    v_mfma_f32_32x32x16_bf16 v[32:47], v[72:75], a[16:19], v[32:47]
    ds_read_b64_tr_b16 v[64:65], v6 offset:12288
    ds_read_b64_tr_b16 v[66:67], v6 offset:13312
    s_add_u32 s90, s89, 16384
    buffer_load_dwordx4 a[64:67], v2, s[40:43], s90 offen sc1
    v_mfma_f32_32x32x16_bf16 v[48:63], v[76:79], a[16:19], v[48:63]
    ds_read_b64_tr_b16 v[68:69], v7 offset:12288
    ds_read_b64_tr_b16 v[70:71], v7 offset:13312
    s_waitcnt vmcnt(11)
    s_waitcnt lgkmcnt(4)
    v_mfma_f32_32x32x16_bf16 v[32:47], v[80:83], a[20:23], v[32:47]
    ds_read_b64_tr_b16 v[72:73], v8 offset:0
    ds_read_b64_tr_b16 v[74:75], v8 offset:1024
    buffer_load_dwordx4 a[68:71], v2, s[40:43], s90 offen offset:1024 sc1
    v_mfma_f32_32x32x16_bf16 v[48:63], v[84:87], a[20:23], v[48:63]
    ds_read_b64_tr_b16 v[76:77], v9 offset:0
    ds_read_b64_tr_b16 v[78:79], v9 offset:1024
    s_waitcnt vmcnt(11)
    s_waitcnt lgkmcnt(4)
    v_mfma_f32_32x32x16_bf16 v[32:47], v[64:67], a[24:27], v[32:47]
    ds_read_b64_tr_b16 v[80:81], v8 offset:2048
    ds_read_b64_tr_b16 v[82:83], v8 offset:3072
    buffer_load_dwordx4 a[72:75], v2, s[40:43], s90 offen offset:2048 sc1
    v_mfma_f32_32x32x16_bf16 v[48:63], v[68:71], a[24:27], v[48:63]
    ds_read_b64_tr_b16 v[84:85], v9 offset:2048
    ds_read_b64_tr_b16 v[86:87], v9 offset:3072
    s_waitcnt vmcnt(11)
    s_waitcnt lgkmcnt(4)
    v_mfma_f32_32x32x16_bf16 v[32:47], v[72:75], a[28:31], v[32:47]
    s_barrier
    ds_read_b64_tr_b16 v[64:65], v8 offset:4096
    ds_read_b64_tr_b16 v[66:67], v8 offset:5120
    buffer_load_dwordx4 a[76:79], v2, s[40:43], s90 offen offset:3072 sc1
    v_mfma_f32_32x32x16_bf16 v[48:63], v[76:79], a[28:31], v[48:63]
    ds_read_b64_tr_b16 v[68:69], v9 offset:4096
    ds_read_b64_tr_b16 v[70:71], v9 offset:5120
    s_waitcnt vmcnt(11)
    s_waitcnt lgkmcnt(4)
    v_mfma_f32_32x32x16_bf16 v[32:47], v[80:83], a[32:35], v[32:47]
    ds_read_b64_tr_b16 v[72:73], v8 offset:6144
    ds_read_b64_tr_b16 v[74:75], v8 offset:7168
    s_add_u32 s90, s89, 20480
    buffer_load_dwordx4 a[80:83], v2, s[40:43], s90 offen sc1
    v_mfma_f32_32x32x16_bf16 v[48:63], v[84:87], a[32:35], v[48:63]
    ds_read_b64_tr_b16 v[76:77], v9 offset:6144
    ds_read_b64_tr_b16 v[78:79], v9 offset:7168
    s_mul_i32 s56, s64, 2
    s_min_u32 s56, s56, 4
    s_mul_i32 s57, s82, 1
    s_add_u32 s56, s56, s57
    s_lshl_b32 s84, s83, 11
    s_mul_i32 s57, s96, 1
    s_mul_i32 s57, s57, s83
    s_add_u32 s56, s56, s57
    s_mul_i32 s95, s96, 2
    s_mul_i32 s95, s95, s83
    s_lshl_b32 s65, s56, 11
    s_add_u32 s65, s65, 18432
    s_add_u32 s98, s56, 37
    s_lshl_b32 s66, s98, 14
    s_add_u32 s66, s66, s87
    s_mov_b32 m0, s65
    s_nop 0
    buffer_load_dwordx4 v5, s[28:31], s66 offen lds
    s_waitcnt vmcnt(12)
    s_waitcnt lgkmcnt(4)
    v_mfma_f32_32x32x16_bf16 v[32:47], v[64:67], a[36:39], v[32:47]
    ds_read_b64_tr_b16 v[80:81], v8 offset:8192
    ds_read_b64_tr_b16 v[82:83], v8 offset:9216
    buffer_load_dwordx4 a[84:87], v2, s[40:43], s90 offen offset:1024 sc1
    v_mfma_f32_32x32x16_bf16 v[48:63], v[68:71], a[36:39], v[48:63]
    ds_read_b64_tr_b16 v[84:85], v9 offset:8192
    ds_read_b64_tr_b16 v[86:87], v9 offset:9216
    s_waitcnt vmcnt(12)
    s_waitcnt lgkmcnt(4)
    v_mfma_f32_32x32x16_bf16 v[32:47], v[72:75], a[40:43], v[32:47]
    ds_read_b64_tr_b16 v[64:65], v8 offset:10240
    ds_read_b64_tr_b16 v[66:67], v8 offset:11264
    buffer_load_dwordx4 a[88:91], v2, s[40:43], s90 offen offset:2048 sc1
    v_mfma_f32_32x32x16_bf16 v[48:63], v[76:79], a[40:43], v[48:63]
    ds_read_b64_tr_b16 v[68:69], v9 offset:10240
    ds_read_b64_tr_b16 v[70:71], v9 offset:11264
    s_waitcnt vmcnt(12)
    s_waitcnt lgkmcnt(4)
    v_mfma_f32_32x32x16_bf16 v[32:47], v[80:83], a[44:47], v[32:47]
    ds_read_b64_tr_b16 v[72:73], v8 offset:12288
    ds_read_b64_tr_b16 v[74:75], v8 offset:13312
    buffer_load_dwordx4 a[92:95], v2, s[40:43], s90 offen offset:3072 sc1
    buffer_load_dwordx4 v20, s[28:31], s66 offen offset:1024 lds
    s_sub_u32 s56, s83, s95
    s_add_u32 s98, s98, s56
    s_lshl_b32 s56, s56, 11
    s_add_u32 s65, s65, s56
    v_mfma_f32_32x32x16_bf16 v[48:63], v[84:87], a[44:47], v[48:63]
    ds_read_b64_tr_b16 v[76:77], v9 offset:12288
    ds_read_b64_tr_b16 v[78:79], v9 offset:13312
    s_waitcnt vmcnt(13)
    s_waitcnt lgkmcnt(4)
    v_mfma_f32_32x32x16_bf16 v[32:47], v[64:67], a[48:51], v[32:47]
    ds_read_b64_tr_b16 v[80:81], v10 offset:0
    ds_read_b64_tr_b16 v[82:83], v10 offset:1024
    s_add_u32 s90, s89, 24576
    buffer_load_dwordx4 a[96:99], v2, s[40:43], s90 offen sc1
    v_mfma_f32_32x32x16_bf16 v[48:63], v[68:71], a[48:51], v[48:63]
    ds_read_b64_tr_b16 v[84:85], v11 offset:0
    ds_read_b64_tr_b16 v[86:87], v11 offset:1024
    s_waitcnt vmcnt(13)
    s_waitcnt lgkmcnt(4)
    v_mfma_f32_32x32x16_bf16 v[32:47], v[72:75], a[52:55], v[32:47]
    ds_read_b64_tr_b16 v[64:65], v10 offset:2048
    ds_read_b64_tr_b16 v[66:67], v10 offset:3072
    buffer_load_dwordx4 a[100:103], v2, s[40:43], s90 offen offset:1024 sc1
    v_mfma_f32_32x32x16_bf16 v[48:63], v[76:79], a[52:55], v[48:63]
    ds_read_b64_tr_b16 v[68:69], v11 offset:2048
    ds_read_b64_tr_b16 v[70:71], v11 offset:3072
    s_lshl_b32 s66, s98, 14
    s_add_u32 s66, s66, s87
    s_mov_b32 m0, s65
    s_nop 0
    buffer_load_dwordx4 v5, s[28:31], s66 offen lds
    s_waitcnt vmcnt(14)
    s_waitcnt lgkmcnt(4)
    v_mfma_f32_32x32x16_bf16 v[32:47], v[80:83], a[56:59], v[32:47]
    ds_read_b64_tr_b16 v[72:73], v10 offset:4096
    ds_read_b64_tr_b16 v[74:75], v10 offset:5120
    buffer_load_dwordx4 a[104:107], v2, s[40:43], s90 offen offset:2048 sc1
    v_mfma_f32_32x32x16_bf16 v[48:63], v[84:87], a[56:59], v[48:63]
    ds_read_b64_tr_b16 v[76:77], v11 offset:4096
    ds_read_b64_tr_b16 v[78:79], v11 offset:5120
    s_waitcnt vmcnt(14)
    s_waitcnt lgkmcnt(4)
    v_mfma_f32_32x32x16_bf16 v[32:47], v[64:67], a[60:63], v[32:47]
    ds_read_b64_tr_b16 v[80:81], v10 offset:6144
    ds_read_b64_tr_b16 v[82:83], v10 offset:7168
    buffer_load_dwordx4 a[108:111], v2, s[40:43], s90 offen offset:3072 sc1
    v_mfma_f32_32x32x16_bf16 v[48:63], v[68:71], a[60:63], v[48:63]
    ds_read_b64_tr_b16 v[84:85], v11 offset:6144
    ds_read_b64_tr_b16 v[86:87], v11 offset:7168
    s_waitcnt vmcnt(14)
    s_waitcnt lgkmcnt(4)
    v_mfma_f32_32x32x16_bf16 v[32:47], v[72:75], a[64:67], v[32:47]
    ds_read_b64_tr_b16 v[64:65], v10 offset:8192
    ds_read_b64_tr_b16 v[66:67], v10 offset:9216
    s_add_u32 s90, s89, 28672
    buffer_load_dwordx4 a[112:115], v2, s[40:43], s90 offen sc1
    buffer_load_dwordx4 v20, s[28:31], s66 offen offset:1024 lds
    v_mfma_f32_32x32x16_bf16 v[48:63], v[76:79], a[64:67], v[48:63]
    ds_read_b64_tr_b16 v[68:69], v11 offset:8192
    ds_read_b64_tr_b16 v[70:71], v11 offset:9216
    s_waitcnt vmcnt(15)
    s_waitcnt lgkmcnt(4)
    v_mfma_f32_32x32x16_bf16 v[32:47], v[80:83], a[68:71], v[32:47]
    ds_read_b64_tr_b16 v[72:73], v10 offset:10240
    ds_read_b64_tr_b16 v[74:75], v10 offset:11264
    buffer_load_dwordx4 a[116:119], v2, s[40:43], s90 offen offset:1024 sc1
    v_mfma_f32_32x32x16_bf16 v[48:63], v[84:87], a[68:71], v[48:63]
    ds_read_b64_tr_b16 v[76:77], v11 offset:10240
    ds_read_b64_tr_b16 v[78:79], v11 offset:11264
    s_waitcnt vmcnt(15)
    s_waitcnt lgkmcnt(4)
    v_mfma_f32_32x32x16_bf16 v[32:47], v[64:67], a[72:75], v[32:47]
    ds_read_b64_tr_b16 v[80:81], v10 offset:12288
    ds_read_b64_tr_b16 v[82:83], v10 offset:13312
    buffer_load_dwordx4 a[120:123], v2, s[40:43], s90 offen offset:2048 sc1
    v_mfma_f32_32x32x16_bf16 v[48:63], v[68:71], a[72:75], v[48:63]
    ds_read_b64_tr_b16 v[84:85], v11 offset:12288
    ds_read_b64_tr_b16 v[86:87], v11 offset:13312
    s_waitcnt vmcnt(15)
    s_waitcnt lgkmcnt(4)
    v_mfma_f32_32x32x16_bf16 v[32:47], v[72:75], a[76:79], v[32:47]
    ds_read_b64_tr_b16 v[64:65], v10 offset:14336
    ds_read_b64_tr_b16 v[66:67], v10 offset:15360
    buffer_load_dwordx4 a[124:127], v2, s[40:43], s90 offen offset:3072 sc1
    s_mul_i32 s56, s64, 2
    s_min_u32 s56, s56, 4
    s_mul_i32 s57, s82, 1
    s_add_u32 s56, s56, s57
    s_lshl_b32 s84, s83, 11
    s_mul_i32 s57, s96, 1
    s_mul_i32 s57, s57, s83
    s_add_u32 s56, s56, s57
    s_mul_i32 s95, s96, 2
    s_mul_i32 s95, s95, s83
    s_lshl_b32 s65, s56, 11
    s_add_u32 s65, s65, 32768
    s_add_u32 s98, s56, 37
    s_lshl_b32 s66, s98, 14
    s_add_u32 s66, s66, s87
    s_add_u32 s66, s66, 704512
    s_mov_b32 m0, s65
    s_nop 0
    buffer_load_dwordx4 v5, s[28:31], s66 offen lds
    v_mfma_f32_32x32x16_bf16 v[48:63], v[76:79], a[76:79], v[48:63]
    ds_read_b64_tr_b16 v[68:69], v11 offset:14336
    ds_read_b64_tr_b16 v[70:71], v11 offset:15360
    s_waitcnt vmcnt(16)
    s_waitcnt lgkmcnt(4)
    v_mfma_f32_32x32x16_bf16 v[32:47], v[80:83], a[80:83], v[32:47]
    ds_read_b64_tr_b16 v[72:73], v10 offset:16384
    ds_read_b64_tr_b16 v[74:75], v10 offset:17408
    s_add_u32 s90, s89, 32768
    buffer_load_dwordx4 a[144:147], v2, s[40:43], s90 offen sc1
    v_mfma_f32_32x32x16_bf16 v[48:63], v[84:87], a[80:83], v[48:63]
    ds_read_b64_tr_b16 v[76:77], v11 offset:16384
    ds_read_b64_tr_b16 v[78:79], v11 offset:17408
    s_waitcnt vmcnt(15)
    s_waitcnt lgkmcnt(4)
    v_mfma_f32_32x32x16_bf16 v[32:47], v[64:67], a[84:87], v[32:47]
    ds_read_b64_tr_b16 v[80:81], v10 offset:18432
    ds_read_b64_tr_b16 v[82:83], v10 offset:19456
    buffer_load_dwordx4 a[148:151], v2, s[40:43], s90 offen offset:1024 sc1
    v_mfma_f32_32x32x16_bf16 v[48:63], v[68:71], a[84:87], v[48:63]
    ds_read_b64_tr_b16 v[84:85], v11 offset:18432
    ds_read_b64_tr_b16 v[86:87], v11 offset:19456
    buffer_load_dwordx4 v20, s[28:31], s66 offen offset:1024 lds
    s_sub_u32 s56, s83, s95
    s_add_u32 s98, s98, s56
    s_lshl_b32 s56, s56, 11
    s_add_u32 s65, s65, s56
    s_waitcnt vmcnt(16)
    s_waitcnt lgkmcnt(4)
    v_mfma_f32_32x32x16_bf16 v[32:47], v[72:75], a[88:91], v[32:47]
    ds_read_b64_tr_b16 v[64:65], v10 offset:20480
    ds_read_b64_tr_b16 v[66:67], v10 offset:21504
    buffer_load_dwordx4 a[152:155], v2, s[40:43], s90 offen offset:2048 sc1
    v_mfma_f32_32x32x16_bf16 v[48:63], v[76:79], a[88:91], v[48:63]
    ds_read_b64_tr_b16 v[68:69], v11 offset:20480
    ds_read_b64_tr_b16 v[70:71], v11 offset:21504
    s_waitcnt vmcnt(16)
    s_waitcnt lgkmcnt(4)
    v_mfma_f32_32x32x16_bf16 v[32:47], v[80:83], a[92:95], v[32:47]
    ds_read_b64_tr_b16 v[72:73], v10 offset:22528
    ds_read_b64_tr_b16 v[74:75], v10 offset:23552
    buffer_load_dwordx4 a[156:159], v2, s[40:43], s90 offen offset:3072 sc1
    v_mfma_f32_32x32x16_bf16 v[48:63], v[84:87], a[92:95], v[48:63]
    ds_read_b64_tr_b16 v[76:77], v11 offset:22528
    ds_read_b64_tr_b16 v[78:79], v11 offset:23552
    s_waitcnt vmcnt(15)
    s_waitcnt lgkmcnt(4)
    v_mfma_f32_32x32x16_bf16 v[32:47], v[64:67], a[96:99], v[32:47]
    ds_read_b64_tr_b16 v[80:81], v10 offset:24576
    ds_read_b64_tr_b16 v[82:83], v10 offset:25600
    s_add_u32 s90, s89, 36864
    buffer_load_dwordx4 a[160:163], v2, s[40:43], s90 offen sc1
    s_lshl_b32 s66, s98, 14
    s_add_u32 s66, s66, s87
    s_add_u32 s66, s66, 704512
    s_mov_b32 m0, s65
    s_nop 0
    buffer_load_dwordx4 v5, s[28:31], s66 offen lds
    v_mfma_f32_32x32x16_bf16 v[48:63], v[68:71], a[96:99], v[48:63]
    ds_read_b64_tr_b16 v[84:85], v11 offset:24576
    ds_read_b64_tr_b16 v[86:87], v11 offset:25600
    s_waitcnt vmcnt(16)
    s_waitcnt lgkmcnt(4)
    v_mfma_f32_32x32x16_bf16 v[32:47], v[72:75], a[100:103], v[32:47]
    ds_read_b64_tr_b16 v[64:65], v10 offset:26624
    ds_read_b64_tr_b16 v[66:67], v10 offset:27648
    buffer_load_dwordx4 a[164:167], v2, s[40:43], s90 offen offset:1024 sc1
    v_mfma_f32_32x32x16_bf16 v[48:63], v[76:79], a[100:103], v[48:63]
    ds_read_b64_tr_b16 v[68:69], v11 offset:26624
    ds_read_b64_tr_b16 v[70:71], v11 offset:27648
    s_waitcnt vmcnt(15)
    s_waitcnt lgkmcnt(4)
    v_mfma_f32_32x32x16_bf16 v[32:47], v[80:83], a[104:107], v[32:47]
    ds_read_b64_tr_b16 v[72:73], v10 offset:28672
    ds_read_b64_tr_b16 v[74:75], v10 offset:29696
    buffer_load_dwordx4 a[168:171], v2, s[40:43], s90 offen offset:2048 sc1
    v_mfma_f32_32x32x16_bf16 v[48:63], v[84:87], a[104:107], v[48:63]
    ds_read_b64_tr_b16 v[76:77], v11 offset:28672
    ds_read_b64_tr_b16 v[78:79], v11 offset:29696
    buffer_load_dwordx4 v20, s[28:31], s66 offen offset:1024 lds
    s_waitcnt vmcnt(16)
    s_waitcnt lgkmcnt(4)
    v_mfma_f32_32x32x16_bf16 v[32:47], v[64:67], a[108:111], v[32:47]
    ds_read_b64_tr_b16 v[80:81], v30 offset:0
    ds_read_b64_tr_b16 v[82:83], v30 offset:1024
    buffer_load_dwordx4 a[172:175], v2, s[40:43], s90 offen offset:3072 sc1
    v_mfma_f32_32x32x16_bf16 v[48:63], v[68:71], a[108:111], v[48:63]
    ds_read_b64_tr_b16 v[84:85], v31 offset:0
    ds_read_b64_tr_b16 v[86:87], v31 offset:1024
    s_waitcnt vmcnt(16)
    s_waitcnt lgkmcnt(4)
    v_mfma_f32_32x32x16_bf16 v[32:47], v[72:75], a[112:115], v[32:47]
    ds_read_b64_tr_b16 v[64:65], v30 offset:2048
    ds_read_b64_tr_b16 v[66:67], v30 offset:3072
    s_add_u32 s90, s89, 40960
    buffer_load_dwordx4 a[176:179], v2, s[40:43], s90 offen sc1
    v_mfma_f32_32x32x16_bf16 v[48:63], v[76:79], a[112:115], v[48:63]
    ds_read_b64_tr_b16 v[68:69], v31 offset:2048
    ds_read_b64_tr_b16 v[70:71], v31 offset:3072
    s_waitcnt vmcnt(15)
    s_waitcnt lgkmcnt(4)
    v_mfma_f32_32x32x16_bf16 v[32:47], v[80:83], a[116:119], v[32:47]
    ds_read_b64_tr_b16 v[72:73], v30 offset:4096
    ds_read_b64_tr_b16 v[74:75], v30 offset:5120
    buffer_load_dwordx4 a[180:183], v2, s[40:43], s90 offen offset:1024 sc1
    v_mfma_f32_32x32x16_bf16 v[48:63], v[84:87], a[116:119], v[48:63]
    ds_read_b64_tr_b16 v[76:77], v31 offset:4096
    ds_read_b64_tr_b16 v[78:79], v31 offset:5120
    s_waitcnt vmcnt(15)
    s_waitcnt lgkmcnt(4)
    v_mfma_f32_32x32x16_bf16 v[32:47], v[64:67], a[120:123], v[32:47]
    ds_read_b64_tr_b16 v[80:81], v30 offset:6144
    ds_read_b64_tr_b16 v[82:83], v30 offset:7168
    buffer_load_dwordx4 a[184:187], v2, s[40:43], s90 offen offset:2048 sc1
    v_mfma_f32_32x32x16_bf16 v[48:63], v[68:71], a[120:123], v[48:63]
    ds_read_b64_tr_b16 v[84:85], v31 offset:6144
    ds_read_b64_tr_b16 v[86:87], v31 offset:7168
    s_waitcnt vmcnt(15)
    s_waitcnt lgkmcnt(4)
    v_mfma_f32_32x32x16_bf16 v[32:47], v[72:75], a[124:127], v[32:47]
    ds_read_b64_tr_b16 v[64:65], v28 offset:0
    ds_read_b64_tr_b16 v[66:67], v28 offset:1024
    v_mfma_f32_32x32x16_bf16 v[48:63], v[76:79], a[124:127], v[48:63]
    ds_read_b64_tr_b16 v[68:69], v29 offset:0
    ds_read_b64_tr_b16 v[70:71], v29 offset:1024
    s_waitcnt vmcnt(13)
    s_waitcnt lgkmcnt(4)
    v_mfma_f32_32x32x16_bf16 v[32:47], v[80:83], a[144:147], v[32:47]
    ds_read_b64_tr_b16 v[72:73], v28 offset:2048
    ds_read_b64_tr_b16 v[74:75], v28 offset:3072
    v_mfma_f32_32x32x16_bf16 v[48:63], v[84:87], a[144:147], v[48:63]
    ds_read_b64_tr_b16 v[76:77], v29 offset:2048
    ds_read_b64_tr_b16 v[78:79], v29 offset:3072
    s_waitcnt vmcnt(12)
    s_waitcnt lgkmcnt(4)
    v_mfma_f32_32x32x16_bf16 v[32:47], v[64:67], a[148:151], v[32:47]
    ds_read_b64_tr_b16 v[80:81], v28 offset:4096
    ds_read_b64_tr_b16 v[82:83], v28 offset:5120
    v_mfma_f32_32x32x16_bf16 v[48:63], v[68:71], a[148:151], v[48:63]
    ds_read_b64_tr_b16 v[84:85], v29 offset:4096
    ds_read_b64_tr_b16 v[86:87], v29 offset:5120
    s_waitcnt vmcnt(10)
    s_waitcnt lgkmcnt(4)
    v_mfma_f32_32x32x16_bf16 v[32:47], v[72:75], a[152:155], v[32:47]
    ds_read_b64_tr_b16 v[64:65], v28 offset:6144
    ds_read_b64_tr_b16 v[66:67], v28 offset:7168
    v_mfma_f32_32x32x16_bf16 v[48:63], v[76:79], a[152:155], v[48:63]
    ds_read_b64_tr_b16 v[68:69], v29 offset:6144
    ds_read_b64_tr_b16 v[70:71], v29 offset:7168
    s_waitcnt vmcnt(9)
    s_waitcnt lgkmcnt(4)
    v_mfma_f32_32x32x16_bf16 v[32:47], v[80:83], a[156:159], v[32:47]
    s_waitcnt vmcnt(4)
    s_barrier
    ds_read_b64_tr_b16 v[72:73], v6 offset:0
    ds_read_b64_tr_b16 v[74:75], v6 offset:1024
    v_mfma_f32_32x32x16_bf16 v[48:63], v[84:87], a[156:159], v[48:63]
    ds_read_b64_tr_b16 v[76:77], v7 offset:0
    ds_read_b64_tr_b16 v[78:79], v7 offset:1024
    s_waitcnt lgkmcnt(4)
    v_mfma_f32_32x32x16_bf16 v[32:47], v[64:67], a[160:163], v[32:47]
    ds_read_b64_tr_b16 v[80:81], v6 offset:2048
    ds_read_b64_tr_b16 v[82:83], v6 offset:3072
    v_mfma_f32_32x32x16_bf16 v[48:63], v[68:71], a[160:163], v[48:63]
    ds_read_b64_tr_b16 v[84:85], v7 offset:2048
    ds_read_b64_tr_b16 v[86:87], v7 offset:3072
    s_waitcnt lgkmcnt(4)
    v_mfma_f32_32x32x16_bf16 v[32:47], v[72:75], a[164:167], v[32:47]
    ds_read_b64_tr_b16 v[64:65], v6 offset:4096
    ds_read_b64_tr_b16 v[66:67], v6 offset:5120
    v_mfma_f32_32x32x16_bf16 v[48:63], v[76:79], a[164:167], v[48:63]
    ds_read_b64_tr_b16 v[68:69], v7 offset:4096
    ds_read_b64_tr_b16 v[70:71], v7 offset:5120
    s_waitcnt lgkmcnt(4)
    v_mfma_f32_32x32x16_bf16 v[32:47], v[80:83], a[168:171], v[32:47]
    ds_read_b64_tr_b16 v[72:73], v6 offset:6144
    ds_read_b64_tr_b16 v[74:75], v6 offset:7168
    v_mfma_f32_32x32x16_bf16 v[48:63], v[84:87], a[168:171], v[48:63]
    ds_read_b64_tr_b16 v[76:77], v7 offset:6144
    ds_read_b64_tr_b16 v[78:79], v7 offset:7168
    s_waitcnt vmcnt(3)
    s_waitcnt lgkmcnt(4)
    v_mfma_f32_32x32x16_bf16 v[32:47], v[64:67], a[172:175], v[32:47]
    ds_read_b64_tr_b16 v[80:81], v6 offset:8192
    ds_read_b64_tr_b16 v[82:83], v6 offset:9216
    v_mfma_f32_32x32x16_bf16 v[48:63], v[68:71], a[172:175], v[48:63]
    ds_read_b64_tr_b16 v[84:85], v7 offset:8192
    ds_read_b64_tr_b16 v[86:87], v7 offset:9216
    s_waitcnt vmcnt(2)
    s_waitcnt lgkmcnt(4)
    v_mfma_f32_32x32x16_bf16 v[32:47], v[72:75], a[176:179], v[32:47]
    ds_read_b64_tr_b16 v[64:65], v6 offset:10240
    ds_read_b64_tr_b16 v[66:67], v6 offset:11264
    v_mfma_f32_32x32x16_bf16 v[48:63], v[76:79], a[176:179], v[48:63]
    ds_read_b64_tr_b16 v[68:69], v7 offset:10240
    ds_read_b64_tr_b16 v[70:71], v7 offset:11264
    s_waitcnt vmcnt(1)
    s_waitcnt lgkmcnt(4)
    v_mfma_f32_32x32x16_bf16 v[32:47], v[80:83], a[180:183], v[32:47]
    v_mfma_f32_32x32x16_bf16 v[48:63], v[84:87], a[180:183], v[48:63]
    s_waitcnt vmcnt(0)
    s_waitcnt lgkmcnt(0)
    v_mfma_f32_32x32x16_bf16 v[32:47], v[64:67], a[184:187], v[32:47]
    v_mfma_f32_32x32x16_bf16 v[48:63], v[68:71], a[184:187], v[48:63]
    s_barrier
    s_lshl_b32 s56, s46, 12
    s_add_u32 s56, s56, 98304
    v_add_u32 v12, s56, v2
    v_xor_b32 v13, 8192, v12
    s_nop 6
    ds_write_b128 v12, v[48:51] offset:0
    ds_write_b128 v12, v[52:55] offset:1024
    ds_write_b128 v12, v[56:59] offset:2048
    ds_write_b128 v12, v[60:63] offset:3072
    s_waitcnt lgkmcnt(0)
    s_barrier
    ds_read_b128 v[48:51], v13 offset:0
    ds_read_b128 v[52:55], v13 offset:1024
    ds_read_b128 v[56:59], v13 offset:2048
    ds_read_b128 v[60:63], v13 offset:3072
    s_waitcnt lgkmcnt(0)
    v_add_f32 v32, v32, v48
    v_add_f32 v33, v33, v49
    v_add_f32 v34, v34, v50
    v_add_f32 v35, v35, v51
    v_add_f32 v36, v36, v52
    v_add_f32 v37, v37, v53
    v_add_f32 v38, v38, v54
    v_add_f32 v39, v39, v55
    v_add_f32 v40, v40, v56
    v_add_f32 v41, v41, v57
    v_add_f32 v42, v42, v58
    v_add_f32 v43, v43, v59
    v_add_f32 v44, v44, v60
    v_add_f32 v45, v45, v61
    v_add_f32 v46, v46, v62
    v_add_f32 v47, v47, v63
    v_accvgpr_read_b32 v64, a128
    v_accvgpr_read_b32 v65, a129
    v_accvgpr_read_b32 v66, a130
    v_accvgpr_read_b32 v67, a131
    v_accvgpr_read_b32 v68, a132
    v_accvgpr_read_b32 v69, a133
    v_accvgpr_read_b32 v70, a134
    v_accvgpr_read_b32 v71, a135
    v_accvgpr_read_b32 v72, a136
    v_accvgpr_read_b32 v73, a137
    v_accvgpr_read_b32 v74, a138
    v_accvgpr_read_b32 v75, a139
    v_accvgpr_read_b32 v76, a140
    v_accvgpr_read_b32 v77, a141
    v_accvgpr_read_b32 v78, a142
    v_accvgpr_read_b32 v79, a143
    v_add_f32 v32, v32, v64
    v_add_f32 v33, v33, v65
    v_add_f32 v34, v34, v66
    v_add_f32 v35, v35, v67
    v_add_f32 v36, v36, v68
    v_add_f32 v37, v37, v69
    v_add_f32 v38, v38, v70
    v_add_f32 v39, v39, v71
    v_add_f32 v40, v40, v72
    v_add_f32 v41, v41, v73
    v_add_f32 v42, v42, v74
    v_add_f32 v43, v43, v75
    v_add_f32 v44, v44, v76
    v_add_f32 v45, v45, v77
    v_add_f32 v46, v46, v78
    v_add_f32 v47, v47, v79
    v_cvt_pk_bf16_f32 v64, v32, v33
    v_cvt_pk_bf16_f32 v65, v34, v35
    v_cvt_pk_bf16_f32 v66, v36, v37
    v_cvt_pk_bf16_f32 v67, v38, v39
    v_cvt_pk_bf16_f32 v68, v40, v41
    v_cvt_pk_bf16_f32 v69, v42, v43
    v_cvt_pk_bf16_f32 v70, v44, v45
    v_cvt_pk_bf16_f32 v71, v46, v47
    v_permlane32_swap_b32 v64, v66
    v_permlane32_swap_b32 v65, v67
    v_permlane32_swap_b32 v68, v70
    v_permlane32_swap_b32 v69, v71
    v_and_b32 v12, 31, v1
    v_lshrrev_b32 v13, 5, v1
    v_lshlrev_b32 v12, 10, v12
    v_lshl_add_u32 v14, v13, 4, v12
    s_lshl_b32 s57, s51, 15
    s_lshl_b32 s58, s54, 6
    s_add_u32 s57, s57, s58
    buffer_store_dwordx4 v[64:67], v14, s[32:35], s57 offen
    buffer_store_dwordx4 v[68:71], v14, s[32:35], s57 offen offset:32
L_finish:
    s_waitcnt vmcnt(0) lgkmcnt(0)
    s_cmp_eq_u32 s69, 0
    s_cbranch_scc1 L_noerr_92
    v_mov_b32 v12, s69
    v_mov_b32 v13, 4
    buffer_store_dword v12, v13, s[36:39], 0 offen
L_noerr_92:
    s_waitcnt vmcnt(0)
L_exit:
    s_endpgm
L_rare_30:
    s_nop 7
    v_mov_b32 v160, v13
    v_mov_b32 v161, v13
    v_mov_b32 v162, v13
    v_mov_b32 v163, v13
    v_mov_b32 v164, v13
    v_mov_b32 v165, v13
    v_mov_b32 v166, v13
    v_mov_b32 v167, v13
    v_mov_b32 v168, v13
    v_mov_b32 v169, v13
    v_mov_b32 v170, v13
    v_mov_b32 v171, v13
    v_mov_b32 v172, v13
    v_mov_b32 v173, v13
    v_mov_b32 v174, v13
    v_mov_b32 v175, v13
    v_mov_b32 v200, v13
    v_mov_b32 v201, v13
    v_mov_b32 v202, v13
    v_mov_b32 v203, v13
    v_mov_b32 v204, v13
    v_mov_b32 v205, v13
    v_mov_b32 v206, v13
    v_mov_b32 v207, v13
    v_mov_b32 v208, v13
    v_mov_b32 v209, v13
    v_mov_b32 v210, v13
    v_mov_b32 v211, v13
    v_mov_b32 v212, v13
    v_mov_b32 v213, v13
    v_mov_b32 v214, v13
    v_mov_b32 v215, v13
    s_nop 1
    s_branch L_back_31
L_rare_32:
    s_nop 7
    v_mov_b32 v160, v13
    v_mov_b32 v161, v13
    v_mov_b32 v162, v13
    v_mov_b32 v163, v13
    v_mov_b32 v164, v13
    v_mov_b32 v165, v13
    v_mov_b32 v166, v13
    v_mov_b32 v167, v13
    v_mov_b32 v168, v13
    v_mov_b32 v169, v13
    v_mov_b32 v170, v13
    v_mov_b32 v171, v13
    v_mov_b32 v172, v13
    v_mov_b32 v173, v13
    v_mov_b32 v174, v13
    v_mov_b32 v175, v13
    v_mov_b32 v200, v13
    v_mov_b32 v201, v13
    v_mov_b32 v202, v13
    v_mov_b32 v203, v13
    v_mov_b32 v204, v13
    v_mov_b32 v205, v13
    v_mov_b32 v206, v13
    v_mov_b32 v207, v13
    v_mov_b32 v208, v13
    v_mov_b32 v209, v13
    v_mov_b32 v210, v13
    v_mov_b32 v211, v13
    v_mov_b32 v212, v13
    v_mov_b32 v213, v13
    v_mov_b32 v214, v13
    v_mov_b32 v215, v13
    s_nop 1
    s_branch L_back_33
L_rare_34:
    s_nop 7
    v_mov_b32 v160, v13
    v_mov_b32 v161, v13
    v_mov_b32 v162, v13
    v_mov_b32 v163, v13
    v_mov_b32 v164, v13
    v_mov_b32 v165, v13
    v_mov_b32 v166, v13
    v_mov_b32 v167, v13
    v_mov_b32 v168, v13
    v_mov_b32 v169, v13
    v_mov_b32 v170, v13
    v_mov_b32 v171, v13
    v_mov_b32 v172, v13
    v_mov_b32 v173, v13
    v_mov_b32 v174, v13
    v_mov_b32 v175, v13
    v_mov_b32 v200, v13
    v_mov_b32 v201, v13
    v_mov_b32 v202, v13
    v_mov_b32 v203, v13
    v_mov_b32 v204, v13
    v_mov_b32 v205, v13
    v_mov_b32 v206, v13
    v_mov_b32 v207, v13
    v_mov_b32 v208, v13
    v_mov_b32 v209, v13
    v_mov_b32 v210, v13
    v_mov_b32 v211, v13
    v_mov_b32 v212, v13
    v_mov_b32 v213, v13
    v_mov_b32 v214, v13
    v_mov_b32 v215, v13
    s_nop 1
    s_branch L_back_35
L_rare_36:
    s_nop 7
    v_mov_b32 v160, v13
    v_mov_b32 v161, v13
    v_mov_b32 v162, v13
    v_mov_b32 v163, v13
    v_mov_b32 v164, v13
    v_mov_b32 v165, v13
    v_mov_b32 v166, v13
    v_mov_b32 v167, v13
    v_mov_b32 v168, v13
    v_mov_b32 v169, v13
    v_mov_b32 v170, v13
    v_mov_b32 v171, v13
    v_mov_b32 v172, v13
    v_mov_b32 v173, v13
    v_mov_b32 v174, v13
    v_mov_b32 v175, v13
    v_mov_b32 v200, v13
    v_mov_b32 v201, v13
    v_mov_b32 v202, v13
    v_mov_b32 v203, v13
    v_mov_b32 v204, v13
    v_mov_b32 v205, v13
    v_mov_b32 v206, v13
    v_mov_b32 v207, v13
    v_mov_b32 v208, v13
    v_mov_b32 v209, v13
    v_mov_b32 v210, v13
    v_mov_b32 v211, v13
    v_mov_b32 v212, v13
    v_mov_b32 v213, v13
    v_mov_b32 v214, v13
    v_mov_b32 v215, v13
    s_nop 1
    s_branch L_back_37
L_rare_38:
    s_nop 7
    v_mov_b32 v160, v13
    v_mov_b32 v161, v13
    v_mov_b32 v162, v13
    v_mov_b32 v163, v13
    v_mov_b32 v164, v13
    v_mov_b32 v165, v13
    v_mov_b32 v166, v13
    v_mov_b32 v167, v13
    v_mov_b32 v168, v13
    v_mov_b32 v169, v13
    v_mov_b32 v170, v13
    v_mov_b32 v171, v13
    v_mov_b32 v172, v13
    v_mov_b32 v173, v13
    v_mov_b32 v174, v13
    v_mov_b32 v175, v13
    v_mov_b32 v200, v13
    v_mov_b32 v201, v13
    v_mov_b32 v202, v13
    v_mov_b32 v203, v13
    v_mov_b32 v204, v13
    v_mov_b32 v205, v13
    v_mov_b32 v206, v13
    v_mov_b32 v207, v13
    v_mov_b32 v208, v13
    v_mov_b32 v209, v13
    v_mov_b32 v210, v13
    v_mov_b32 v211, v13
    v_mov_b32 v212, v13
    v_mov_b32 v213, v13
    v_mov_b32 v214, v13
    v_mov_b32 v215, v13
    s_nop 1
    s_branch L_back_39
L_rare_40:
    s_nop 7
    v_mov_b32 v160, v13
    v_mov_b32 v161, v13
    v_mov_b32 v162, v13
    v_mov_b32 v163, v13
    v_mov_b32 v164, v13
    v_mov_b32 v165, v13
    v_mov_b32 v166, v13
    v_mov_b32 v167, v13
    v_mov_b32 v168, v13
    v_mov_b32 v169, v13
    v_mov_b32 v170, v13
    v_mov_b32 v171, v13
    v_mov_b32 v172, v13
    v_mov_b32 v173, v13
    v_mov_b32 v174, v13
    v_mov_b32 v175, v13
    v_mov_b32 v200, v13
    v_mov_b32 v201, v13
    v_mov_b32 v202, v13
    v_mov_b32 v203, v13
    v_mov_b32 v204, v13
    v_mov_b32 v205, v13
    v_mov_b32 v206, v13
    v_mov_b32 v207, v13
    v_mov_b32 v208, v13
    v_mov_b32 v209, v13
    v_mov_b32 v210, v13
    v_mov_b32 v211, v13
    v_mov_b32 v212, v13
    v_mov_b32 v213, v13
    v_mov_b32 v214, v13
    v_mov_b32 v215, v13
    s_nop 1
    s_branch L_back_41
L_rare_42:
    s_nop 7
    v_mov_b32 v160, v13
    v_mov_b32 v161, v13
    v_mov_b32 v162, v13
    v_mov_b32 v163, v13
    v_mov_b32 v164, v13
    v_mov_b32 v165, v13
    v_mov_b32 v166, v13
    v_mov_b32 v167, v13
    v_mov_b32 v168, v13
    v_mov_b32 v169, v13
    v_mov_b32 v170, v13
    v_mov_b32 v171, v13
    v_mov_b32 v172, v13
    v_mov_b32 v173, v13
    v_mov_b32 v174, v13
    v_mov_b32 v175, v13
    v_mov_b32 v200, v13
    v_mov_b32 v201, v13
    v_mov_b32 v202, v13
    v_mov_b32 v203, v13
    v_mov_b32 v204, v13
    v_mov_b32 v205, v13
    v_mov_b32 v206, v13
    v_mov_b32 v207, v13
    v_mov_b32 v208, v13
    v_mov_b32 v209, v13
    v_mov_b32 v210, v13
    v_mov_b32 v211, v13
    v_mov_b32 v212, v13
    v_mov_b32 v213, v13
    v_mov_b32 v214, v13
    v_mov_b32 v215, v13
    s_nop 1
    s_branch L_back_43
L_rare_44:
    s_nop 7
    v_mov_b32 v160, v13
    v_mov_b32 v161, v13
    v_mov_b32 v162, v13
    v_mov_b32 v163, v13
    v_mov_b32 v164, v13
    v_mov_b32 v165, v13
    v_mov_b32 v166, v13
    v_mov_b32 v167, v13
    v_mov_b32 v168, v13
    v_mov_b32 v169, v13
    v_mov_b32 v170, v13
    v_mov_b32 v171, v13
    v_mov_b32 v172, v13
    v_mov_b32 v173, v13
    v_mov_b32 v174, v13
    v_mov_b32 v175, v13
    v_mov_b32 v200, v13
    v_mov_b32 v201, v13
    v_mov_b32 v202, v13
    v_mov_b32 v203, v13
    v_mov_b32 v204, v13
    v_mov_b32 v205, v13
    v_mov_b32 v206, v13
    v_mov_b32 v207, v13
    v_mov_b32 v208, v13
    v_mov_b32 v209, v13
    v_mov_b32 v210, v13
    v_mov_b32 v211, v13
    v_mov_b32 v212, v13
    v_mov_b32 v213, v13
    v_mov_b32 v214, v13
    v_mov_b32 v215, v13
    s_nop 1
    s_branch L_back_45
L_rare_46:
    s_nop 7
    v_mov_b32 v96, v13
    v_mov_b32 v97, v13
    v_mov_b32 v98, v13
    v_mov_b32 v99, v13
    v_mov_b32 v100, v13
    v_mov_b32 v101, v13
    v_mov_b32 v102, v13
    v_mov_b32 v103, v13
    v_mov_b32 v104, v13
    v_mov_b32 v105, v13
    v_mov_b32 v106, v13
    v_mov_b32 v107, v13
    v_mov_b32 v108, v13
    v_mov_b32 v109, v13
    v_mov_b32 v110, v13
    v_mov_b32 v111, v13
    v_mov_b32 v112, v13
    v_mov_b32 v113, v13
    v_mov_b32 v114, v13
    v_mov_b32 v115, v13
    v_mov_b32 v116, v13
    v_mov_b32 v117, v13
    v_mov_b32 v118, v13
    v_mov_b32 v119, v13
    v_mov_b32 v120, v13
    v_mov_b32 v121, v13
    v_mov_b32 v122, v13
    v_mov_b32 v123, v13
    v_mov_b32 v124, v13
    v_mov_b32 v125, v13
    v_mov_b32 v126, v13
    v_mov_b32 v127, v13
    s_nop 1
    s_branch L_back_47
L_rare_48:
    s_nop 7
    v_mov_b32 v96, v13
    v_mov_b32 v97, v13
    v_mov_b32 v98, v13
    v_mov_b32 v99, v13
    v_mov_b32 v100, v13
    v_mov_b32 v101, v13
    v_mov_b32 v102, v13
    v_mov_b32 v103, v13
    v_mov_b32 v104, v13
    v_mov_b32 v105, v13
    v_mov_b32 v106, v13
    v_mov_b32 v107, v13
    v_mov_b32 v108, v13
    v_mov_b32 v109, v13
    v_mov_b32 v110, v13
    v_mov_b32 v111, v13
    v_mov_b32 v112, v13
    v_mov_b32 v113, v13
    v_mov_b32 v114, v13
    v_mov_b32 v115, v13
    v_mov_b32 v116, v13
    v_mov_b32 v117, v13
    v_mov_b32 v118, v13
    v_mov_b32 v119, v13
    v_mov_b32 v120, v13
    v_mov_b32 v121, v13
    v_mov_b32 v122, v13
    v_mov_b32 v123, v13
    v_mov_b32 v124, v13
    v_mov_b32 v125, v13
    v_mov_b32 v126, v13
    v_mov_b32 v127, v13
    s_nop 1
    s_branch L_back_49
L_rare_50:
    s_nop 7
    v_mov_b32 v96, v13
    v_mov_b32 v97, v13
    v_mov_b32 v98, v13
    v_mov_b32 v99, v13
    v_mov_b32 v100, v13
    v_mov_b32 v101, v13
    v_mov_b32 v102, v13
    v_mov_b32 v103, v13
    v_mov_b32 v104, v13
    v_mov_b32 v105, v13
    v_mov_b32 v106, v13
    v_mov_b32 v107, v13
    v_mov_b32 v108, v13
    v_mov_b32 v109, v13
    v_mov_b32 v110, v13
    v_mov_b32 v111, v13
    v_mov_b32 v112, v13
    v_mov_b32 v113, v13
    v_mov_b32 v114, v13
    v_mov_b32 v115, v13
    v_mov_b32 v116, v13
    v_mov_b32 v117, v13
    v_mov_b32 v118, v13
    v_mov_b32 v119, v13
    v_mov_b32 v120, v13
    v_mov_b32 v121, v13
    v_mov_b32 v122, v13
    v_mov_b32 v123, v13
    v_mov_b32 v124, v13
    v_mov_b32 v125, v13
    v_mov_b32 v126, v13
    v_mov_b32 v127, v13
    s_nop 1
    s_branch L_back_51
L_rare_52:
    s_nop 7
    v_mov_b32 v96, v13
    v_mov_b32 v97, v13
    v_mov_b32 v98, v13
    v_mov_b32 v99, v13
    v_mov_b32 v100, v13
    v_mov_b32 v101, v13
    v_mov_b32 v102, v13
    v_mov_b32 v103, v13
    v_mov_b32 v104, v13
    v_mov_b32 v105, v13
    v_mov_b32 v106, v13
    v_mov_b32 v107, v13
    v_mov_b32 v108, v13
    v_mov_b32 v109, v13
    v_mov_b32 v110, v13
    v_mov_b32 v111, v13
    v_mov_b32 v112, v13
    v_mov_b32 v113, v13
    v_mov_b32 v114, v13
    v_mov_b32 v115, v13
    v_mov_b32 v116, v13
    v_mov_b32 v117, v13
    v_mov_b32 v118, v13
    v_mov_b32 v119, v13
    v_mov_b32 v120, v13
    v_mov_b32 v121, v13
    v_mov_b32 v122, v13
    v_mov_b32 v123, v13
    v_mov_b32 v124, v13
    v_mov_b32 v125, v13
    v_mov_b32 v126, v13
    v_mov_b32 v127, v13
    s_nop 1
    s_branch L_back_53
L_rare_54:
    s_nop 7
    v_mov_b32 v96, v13
    v_mov_b32 v97, v13
    v_mov_b32 v98, v13
    v_mov_b32 v99, v13
    v_mov_b32 v100, v13
    v_mov_b32 v101, v13
    v_mov_b32 v102, v13
    v_mov_b32 v103, v13
    v_mov_b32 v104, v13
    v_mov_b32 v105, v13
    v_mov_b32 v106, v13
    v_mov_b32 v107, v13
    v_mov_b32 v108, v13
    v_mov_b32 v109, v13
    v_mov_b32 v110, v13
    v_mov_b32 v111, v13
    v_mov_b32 v112, v13
    v_mov_b32 v113, v13
    v_mov_b32 v114, v13
    v_mov_b32 v115, v13
    v_mov_b32 v116, v13
    v_mov_b32 v117, v13
    v_mov_b32 v118, v13
    v_mov_b32 v119, v13
    v_mov_b32 v120, v13
    v_mov_b32 v121, v13
    v_mov_b32 v122, v13
    v_mov_b32 v123, v13
    v_mov_b32 v124, v13
    v_mov_b32 v125, v13
    v_mov_b32 v126, v13
    v_mov_b32 v127, v13
    s_nop 1
    s_branch L_back_55
L_rare_56:
    s_nop 7
    v_mov_b32 v96, v13
    v_mov_b32 v97, v13
    v_mov_b32 v98, v13
    v_mov_b32 v99, v13
    v_mov_b32 v100, v13
    v_mov_b32 v101, v13
    v_mov_b32 v102, v13
    v_mov_b32 v103, v13
    v_mov_b32 v104, v13
    v_mov_b32 v105, v13
    v_mov_b32 v106, v13
    v_mov_b32 v107, v13
    v_mov_b32 v108, v13
    v_mov_b32 v109, v13
    v_mov_b32 v110, v13
    v_mov_b32 v111, v13
    v_mov_b32 v112, v13
    v_mov_b32 v113, v13
    v_mov_b32 v114, v13
    v_mov_b32 v115, v13
    v_mov_b32 v116, v13
    v_mov_b32 v117, v13
    v_mov_b32 v118, v13
    v_mov_b32 v119, v13
    v_mov_b32 v120, v13
    v_mov_b32 v121, v13
    v_mov_b32 v122, v13
    v_mov_b32 v123, v13
    v_mov_b32 v124, v13
    v_mov_b32 v125, v13
    v_mov_b32 v126, v13
    v_mov_b32 v127, v13
    s_nop 1
    s_branch L_back_57
L_rare_58:
    s_nop 7
    v_mov_b32 v96, v13
    v_mov_b32 v97, v13
    v_mov_b32 v98, v13
    v_mov_b32 v99, v13
    v_mov_b32 v100, v13
    v_mov_b32 v101, v13
    v_mov_b32 v102, v13
    v_mov_b32 v103, v13
    v_mov_b32 v104, v13
    v_mov_b32 v105, v13
    v_mov_b32 v106, v13
    v_mov_b32 v107, v13
    v_mov_b32 v108, v13
    v_mov_b32 v109, v13
    v_mov_b32 v110, v13
    v_mov_b32 v111, v13
    v_mov_b32 v112, v13
    v_mov_b32 v113, v13
    v_mov_b32 v114, v13
    v_mov_b32 v115, v13
    v_mov_b32 v116, v13
    v_mov_b32 v117, v13
    v_mov_b32 v118, v13
    v_mov_b32 v119, v13
    v_mov_b32 v120, v13
    v_mov_b32 v121, v13
    v_mov_b32 v122, v13
    v_mov_b32 v123, v13
    v_mov_b32 v124, v13
    v_mov_b32 v125, v13
    v_mov_b32 v126, v13
    v_mov_b32 v127, v13
    s_nop 1
    s_branch L_back_59
L_rare_60:
    s_nop 7
    v_mov_b32 v96, v13
    v_mov_b32 v97, v13
    v_mov_b32 v98, v13
    v_mov_b32 v99, v13
    v_mov_b32 v100, v13
    v_mov_b32 v101, v13
    v_mov_b32 v102, v13
    v_mov_b32 v103, v13
    v_mov_b32 v104, v13
    v_mov_b32 v105, v13
    v_mov_b32 v106, v13
    v_mov_b32 v107, v13
    v_mov_b32 v108, v13
    v_mov_b32 v109, v13
    v_mov_b32 v110, v13
    v_mov_b32 v111, v13
    v_mov_b32 v112, v13
    v_mov_b32 v113, v13
    v_mov_b32 v114, v13
    v_mov_b32 v115, v13
    v_mov_b32 v116, v13
    v_mov_b32 v117, v13
    v_mov_b32 v118, v13
    v_mov_b32 v119, v13
    v_mov_b32 v120, v13
    v_mov_b32 v121, v13
    v_mov_b32 v122, v13
    v_mov_b32 v123, v13
    v_mov_b32 v124, v13
    v_mov_b32 v125, v13
    v_mov_b32 v126, v13
    v_mov_b32 v127, v13
    s_nop 1
    s_branch L_back_61
.section .rodata,"a"
.p2align 6
.amdhsa_kernel sequential_preLN__sliding_block__geglu_ffn__prompt_kernel
  .amdhsa_next_free_vgpr 512
  .amdhsa_next_free_sgpr 102
  .amdhsa_accum_offset 256
  .amdhsa_group_segment_fixed_size 0
  .amdhsa_kernarg_size 80
  .amdhsa_user_sgpr_count 2
  .amdhsa_user_sgpr_kernarg_segment_ptr 1
  .amdhsa_system_sgpr_workgroup_id_x 1
.end_amdhsa_kernel
```
